```python
import torch

def _softmax(x, axis=-1):
    return torch.softmax(x, dim=axis)
def _gelu(x):
    return torch.nn.functional.gelu(x, approximate="tanh")
def _silu(x):
    return torch.nn.functional.silu(x)
def _sigmoid(x):
    return torch.sigmoid(x)
def _layernorm(x, axis=-1, eps=1e-5):
    m = x.mean(dim=axis, keepdim=True)
    v = x.var(dim=axis, keepdim=True, unbiased=False)
    return (x - m) / torch.sqrt(v + eps)
def _scatter_add(tgt, idx, src, axis=0):
    return tgt.clone().index_add_(axis, idx, src)
def _segment_sum(src, seg, n):
    out = torch.zeros((n,) + src.shape[1:], dtype=src.dtype)
    return out.index_add_(0, seg, src)
def _pad(x, pw):
    flat = tuple(v for pair in reversed(pw) for v in pair)
    return torch.nn.functional.pad(x, flat)

kernel_name = 'sequential_preLN__grouped_kv_mqa__swiglu_ffn__prompt'

def setup_inputs():

    _w = (lambda a: (lambda t: t.to(torch.bfloat16) if t.is_floating_point() else t)(torch.as_tensor(a)))
    def _A_setup():
        B, S, D, H = 1, 2048, 512, 32
        Dh = D // H
        return {
            "x": _w((lambda *s: torch.randn(*s, dtype=torch.bfloat16) * 0.05)(B, S, D)),
            "wq": _w((lambda *s: torch.randn(*s, dtype=torch.bfloat16) * 0.05)(D, H * Dh)),
            "wk": _w((lambda *s: torch.randn(*s, dtype=torch.bfloat16) * 0.05)(D, Dh)),
            "wv": _w((lambda *s: torch.randn(*s, dtype=torch.bfloat16) * 0.05)(D, Dh)),
            "wo": _w((lambda *s: torch.randn(*s, dtype=torch.bfloat16) * 0.05)(H * Dh, D)),
        }
    _A_in = _A_setup()

    def _B_setup():
        B, S, D, F = 1, 2048, 512, 1376
        return {
            "x": _w((lambda *s: torch.randn(*s, dtype=torch.bfloat16) * 0.05)(B, S, D)),
            "w_gate": _w((lambda *s: torch.randn(*s, dtype=torch.bfloat16) * 0.05)(D, F)),
            "w_up": _w((lambda *s: torch.randn(*s, dtype=torch.bfloat16) * 0.05)(D, F)),
            "w_down": _w((lambda *s: torch.randn(*s, dtype=torch.bfloat16) * 0.05)(F, D)),
        }
    _B_in = _B_setup()

    return {
        "A_x": _A_in["x"],
        "A_wq": _A_in["wq"],
        "A_wk": _A_in["wk"],
        "A_wv": _A_in["wv"],
        "A_wo": _A_in["wo"],
        "B_x": _B_in["x"],
        "B_w_gate": _B_in["w_gate"],
        "B_w_up": _B_in["w_up"],
        "B_w_down": _B_in["w_down"],
    }

def reference(A_x, A_wq, A_wk, A_wv, A_wo, B_x, B_w_gate, B_w_up, B_w_down):
    def _A_ref(x, wq, wk, wv, wo):
        B, S, D = x.shape
        H = 32
        Dh = D // H
        q = (lambda x, *d: x.permute(*d))((x @ wq).reshape(B, S, H, Dh), 0, 2, 1, 3)
        k = x @ wk
        v = x @ wv
        scores = torch.einsum("bhqd,bkd->bhqk", q, k) * (Dh ** -0.5)
        p = _softmax(scores, axis=-1)
        o = torch.einsum("bhqk,bkd->bhqd", p, v)
        return (lambda x, *d: x.permute(*d))(o, 0, 2, 1, 3).reshape(B, S, H * Dh) @ wo

    def _B_ref(x, w_gate, w_up, w_down):
        g = _silu(x @ w_gate)
        u = x @ w_up
        return (g * u) @ w_down

    x = A_x
    h = x + _A_ref(_layernorm(x, axis=-1), A_wq, A_wk, A_wv, A_wo)
    h2 = h + _B_ref(_layernorm(h, axis=-1), B_w_gate, B_w_up, B_w_down)
    return h2
```

```asm
; @launch kernel=k1_qkv_kernel grid=(256,1,1) block=(512,1,1) lds=163840
; @launch kernel=k2_attn_kernel grid=(256,1,1) block=(1024,1,1) lds=163840
; @launch kernel=k3_wo_kernel grid=(256,1,1) block=(256,1,1) lds=163840
; @launch kernel=k4_ffn_kernel grid=(248,1,1) block=(256,1,1) lds=100352
; @launch kernel=k5_down_kernel grid=(256,1,1) block=(256,1,1) lds=163840
.amdgcn_target "amdgcn-amd-amdhsa--gfx950"
.text
.globl k1_qkv_kernel
.p2align 8
.type k1_qkv_kernel,@function
k1_qkv_kernel:
    s_load_dwordx16 s[8:23], s[0:1], 0
    s_load_dwordx8 s[24:31], s[0:1], 64
    s_cmp_ge_u32 s2, 256
    s_cbranch_scc1 L_k1_exit
    s_lshr_b32 s5, s2, 3
    s_and_b32 s6, s2, 7
    s_lshr_b32 s3, s5, 3
    s_lshl_b32 s6, s6, 2
    s_add_u32 s3, s3, s6
    s_and_b32 s4, s5, 7
    s_lshl_b32 s46, s3, 6
    v_and_b32 v1, 63, v0
    v_lshrrev_b32 v2, 6, v0
    s_nop 0
    v_readfirstlane_b32 s48, v2
    s_lshr_b32 s53, s48, 2
    s_and_b32 s48, s48, 3
    s_lshl_b32 s52, s48, 10
    s_and_b32 s50, s48, 1
    s_lshr_b32 s51, s48, 1
    v_lshrrev_b32 v2, 4, v1
    s_lshl_b32 s5, s48, 2
    v_add_u32 v2, s5, v2
    v_and_b32 v3, 15, v1
    v_xor_b32 v3, v3, v2
    v_lshlrev_b32 v3, 4, v3
    v_lshl_add_u32 v16, v2, 10, v3
    v_add_u32 v17, 16384, v16
    v_add_u32 v18, 32768, v16
    v_add_u32 v19, 49152, v16
    v_lshrrev_b32 v2, 2, v1
    s_lshl_b32 s5, s48, 4
    v_add_u32 v2, s5, v2
    v_and_b32 v3, 3, v1
    v_lshlrev_b32 v4, 4, v3
    v_lshl_add_u32 v20, v2, 10, v4
    v_add_u32 v21, 65536, v20
    v_and_b32 v4, 1, v3
    v_lshlrev_b32 v4, 4, v4
    v_lshl_add_u32 v4, v2, 5, v4
    v_lshrrev_b32 v5, 1, v3
    v_and_b32 v6, 31, v1
    v_lshrrev_b32 v7, 5, v1
    s_lshl_b32 s5, s50, 13
    v_lshlrev_b32 v33, 8, v6
    v_add_u32 v33, s5, v33
    v_and_b32 v6, 15, v6
    v_add_u32 v2, 0, v7
    v_xor_b32 v2, v2, v6
    v_lshl_add_u32 v26, v2, 4, v33
    v_add_u32 v2, 2, v7
    v_xor_b32 v2, v2, v6
    v_lshl_add_u32 v27, v2, 4, v33
    v_add_u32 v2, 4, v7
    v_xor_b32 v2, v2, v6
    v_lshl_add_u32 v28, v2, 4, v33
    v_add_u32 v2, 6, v7
    v_xor_b32 v2, v2, v6
    v_lshl_add_u32 v29, v2, 4, v33
    v_add_u32 v2, 8, v7
    v_xor_b32 v2, v2, v6
    v_lshl_add_u32 v30, v2, 4, v33
    v_add_u32 v2, 10, v7
    v_xor_b32 v2, v2, v6
    v_lshl_add_u32 v31, v2, 4, v33
    v_add_u32 v2, 12, v7
    v_xor_b32 v2, v2, v6
    v_lshl_add_u32 v32, v2, 4, v33
    v_add_u32 v2, 14, v7
    v_xor_b32 v2, v2, v6
    v_lshl_add_u32 v33, v2, 4, v33
    s_lshl_b32 s5, s51, 13
    s_add_u32 s5, s5, 65536
    v_lshrrev_b32 v3, 5, v1
    v_and_b32 v2, 15, v1
    v_lshrrev_b32 v24, 2, v2
    v_lshl_add_u32 v24, v3, 3, v24
    v_lshlrev_b32 v24, 6, v24
    v_bfe_u32 v3, v1, 4, 1
    v_lshl_add_u32 v24, v3, 5, v24
    v_and_b32 v2, 3, v2
    v_lshl_add_u32 v24, v2, 3, v24
    v_add_u32 v24, s5, v24
    s_sub_u32 s5, 131072, s5
    v_add_u32 v25, s5, v24
    v_mov_b32 v10, 0x3f803f80
    v_mov_b32 v12, 0x3f803f80
    v_mov_b32 v13, 0x3f803f80
    v_mov_b32 v14, 0x3f803f80
    v_mov_b32 v15, 0x3f803f80
    v_mov_b32 v34, 0
    v_mov_b32 v35, 0
    v_mov_b32 v36, 0
    v_mov_b32 v37, 0
    v_mov_b32 v38, 0
    v_mov_b32 v39, 0
    v_mov_b32 v40, 0
    v_mov_b32 v41, 0
    s_waitcnt lgkmcnt(0)
    s_lshl_b32 s5, s46, 10
    s_add_u32 s40, s8, s5
    s_addc_u32 s41, s9, 0
    s_lshl_b32 s5, s4, 7
    s_add_u32 s42, s10, s5
    s_addc_u32 s43, s11, 0
    v_mov_b32 v22, s12
    v_mov_b32 v23, s13
    v_mov_b32 v2, s14
    v_mov_b32 v3, s15
    v_cmp_eq_u32 vcc, 1, v5
    v_cndmask_b32 v22, v22, v2, vcc
    v_cndmask_b32 v23, v23, v3, vcc
    v_add_co_u32 v22, vcc, v22, v4
    v_addc_co_u32 v23, vcc, 0, v23, vcc
    s_cmp_lg_u32 s4, 0
    s_cbranch_scc1 L_k1_q
    s_cmp_eq_u32 s53, 0
    s_cbranch_scc1 L_k1_main_kv
    s_mov_b32 s55, s52
    s_add_u32 s58, s52, 131072
    s_mov_b32 s54, -2
L_k1h_kv_loop:
    s_cmp_lt_i32 s54, 0
    s_cbranch_scc1 L_k1h_kv_iss
    s_waitcnt vmcnt(10)
    s_cmp_lg_u32 s54, 3
    s_cbranch_scc1 L_k1h_kv_nw
    s_waitcnt vmcnt(0)
L_k1h_kv_nw:
    s_barrier
    ds_read_b128 v[52:55], v48
    ds_read_b128 v[56:59], v49
    ds_read_b128 v[60:63], v50
    ds_read_b128 v[64:67], v51
    s_cmp_ge_i32 s54, 2
    s_cbranch_scc1 L_k1h_kv_st
L_k1h_kv_iss:
    s_add_u32 m0, s55, 0
    s_nop 0
    global_load_lds_dwordx4 v16, s[40:41]
    s_add_u32 m0, s55, 4096
    s_nop 0
    global_load_lds_dwordx4 v17, s[40:41]
    s_add_u32 m0, s55, 8192
    s_nop 0
    global_load_lds_dwordx4 v18, s[40:41]
    s_add_u32 m0, s55, 12288
    s_nop 0
    global_load_lds_dwordx4 v19, s[40:41]
    s_add_u32 m0, s55, 65536
    s_nop 0
    global_load_lds_dwordx4 v20, s[42:43]
    s_add_u32 m0, s55, 69632
    s_nop 0
    global_load_lds_dwordx4 v21, s[42:43]
    s_add_u32 m0, s55, 73664
    s_nop 0
    global_load_lds_dwordx4 v20, s[42:43] offset:64
    s_add_u32 m0, s55, 77760
    s_nop 0
    global_load_lds_dwordx4 v21, s[42:43] offset:64
    s_add_u32 m0, s58, 0
    s_nop 0
    global_load_lds_dwordx4 v[22:23], off
    s_add_u32 m0, s58, 2048
    s_nop 0
    global_load_lds_dwordx4 v[22:23], off offset:2048
    v_add_co_u32 v22, vcc, 4096, v22
    v_addc_co_u32 v23, vcc, 0, v23, vcc
    s_add_u32 s58, s58, 8192
    s_add_u32 s40, s40, 256
    s_addc_u32 s41, s41, 0
    s_add_u32 s42, s42, 131072
    s_addc_u32 s43, s43, 0
    s_add_u32 s55, s55, 16384
    s_cmp_ge_i32 s54, 0
    s_cbranch_scc1 L_k1h_kv_st
    s_add_u32 s54, s54, 1
    s_cmp_lt_i32 s54, 0
    s_cbranch_scc1 L_k1h_kv_iss
    v_lshrrev_b32 v2, 2, v1
    s_lshl_b32 s5, s48, 4
    v_add_u32 v2, s5, v2
    v_and_b32 v3, 3, v1
    v_and_b32 v4, 3, v2
    v_lshl_add_u32 v3, v4, 2, v3
    v_add_u32 v4, 0, v3
    v_and_b32 v4, 15, v4
    v_lshlrev_b32 v4, 4, v4
    v_lshl_add_u32 v48, v2, 8, v4
    v_add_u32 v4, 4, v3
    v_and_b32 v4, 15, v4
    v_lshlrev_b32 v4, 4, v4
    v_lshl_add_u32 v49, v2, 8, v4
    v_add_u32 v4, 8, v3
    v_and_b32 v4, 15, v4
    v_lshlrev_b32 v4, 4, v4
    v_lshl_add_u32 v50, v2, 8, v4
    v_add_u32 v4, 12, v3
    v_and_b32 v4, 15, v4
    v_lshlrev_b32 v4, 4, v4
    v_lshl_add_u32 v51, v2, 8, v4
    s_branch L_k1h_kv_loop
L_k1h_kv_st:
    s_waitcnt lgkmcnt(3)
    v_lshlrev_b32 v68, 16, v52
    v_and_b32 v69, 0xffff0000, v52
    v_add_f32 v34, v34, v68
    v_add_f32 v35, v35, v69
    v_fma_f32 v36, v68, v68, v36
    v_fma_f32 v37, v69, v69, v37
    v_lshlrev_b32 v68, 16, v53
    v_and_b32 v69, 0xffff0000, v53
    v_add_f32 v34, v34, v68
    v_add_f32 v35, v35, v69
    v_fma_f32 v36, v68, v68, v36
    v_fma_f32 v37, v69, v69, v37
    v_lshlrev_b32 v68, 16, v54
    v_and_b32 v69, 0xffff0000, v54
    v_add_f32 v34, v34, v68
    v_add_f32 v35, v35, v69
    v_fma_f32 v36, v68, v68, v36
    v_fma_f32 v37, v69, v69, v37
    v_lshlrev_b32 v68, 16, v55
    v_and_b32 v69, 0xffff0000, v55
    v_add_f32 v34, v34, v68
    v_add_f32 v35, v35, v69
    v_fma_f32 v36, v68, v68, v36
    v_fma_f32 v37, v69, v69, v37
    s_waitcnt lgkmcnt(2)
    v_lshlrev_b32 v68, 16, v56
    v_and_b32 v69, 0xffff0000, v56
    v_add_f32 v34, v34, v68
    v_add_f32 v35, v35, v69
    v_fma_f32 v36, v68, v68, v36
    v_fma_f32 v37, v69, v69, v37
    v_lshlrev_b32 v68, 16, v57
    v_and_b32 v69, 0xffff0000, v57
    v_add_f32 v34, v34, v68
    v_add_f32 v35, v35, v69
    v_fma_f32 v36, v68, v68, v36
    v_fma_f32 v37, v69, v69, v37
    v_lshlrev_b32 v68, 16, v58
    v_and_b32 v69, 0xffff0000, v58
    v_add_f32 v34, v34, v68
    v_add_f32 v35, v35, v69
    v_fma_f32 v36, v68, v68, v36
    v_fma_f32 v37, v69, v69, v37
    v_lshlrev_b32 v68, 16, v59
    v_and_b32 v69, 0xffff0000, v59
    v_add_f32 v34, v34, v68
    v_add_f32 v35, v35, v69
    v_fma_f32 v36, v68, v68, v36
    v_fma_f32 v37, v69, v69, v37
    s_waitcnt lgkmcnt(1)
    v_lshlrev_b32 v68, 16, v60
    v_and_b32 v69, 0xffff0000, v60
    v_add_f32 v34, v34, v68
    v_add_f32 v35, v35, v69
    v_fma_f32 v36, v68, v68, v36
    v_fma_f32 v37, v69, v69, v37
    v_lshlrev_b32 v68, 16, v61
    v_and_b32 v69, 0xffff0000, v61
    v_add_f32 v34, v34, v68
    v_add_f32 v35, v35, v69
    v_fma_f32 v36, v68, v68, v36
    v_fma_f32 v37, v69, v69, v37
    v_lshlrev_b32 v68, 16, v62
    v_and_b32 v69, 0xffff0000, v62
    v_add_f32 v34, v34, v68
    v_add_f32 v35, v35, v69
    v_fma_f32 v36, v68, v68, v36
    v_fma_f32 v37, v69, v69, v37
    v_lshlrev_b32 v68, 16, v63
    v_and_b32 v69, 0xffff0000, v63
    v_add_f32 v34, v34, v68
    v_add_f32 v35, v35, v69
    v_fma_f32 v36, v68, v68, v36
    v_fma_f32 v37, v69, v69, v37
    s_waitcnt lgkmcnt(0)
    v_lshlrev_b32 v68, 16, v64
    v_and_b32 v69, 0xffff0000, v64
    v_add_f32 v34, v34, v68
    v_add_f32 v35, v35, v69
    v_fma_f32 v36, v68, v68, v36
    v_fma_f32 v37, v69, v69, v37
    v_lshlrev_b32 v68, 16, v65
    v_and_b32 v69, 0xffff0000, v65
    v_add_f32 v34, v34, v68
    v_add_f32 v35, v35, v69
    v_fma_f32 v36, v68, v68, v36
    v_fma_f32 v37, v69, v69, v37
    v_lshlrev_b32 v68, 16, v66
    v_and_b32 v69, 0xffff0000, v66
    v_add_f32 v34, v34, v68
    v_add_f32 v35, v35, v69
    v_fma_f32 v36, v68, v68, v36
    v_fma_f32 v37, v69, v69, v37
    v_lshlrev_b32 v68, 16, v67
    v_and_b32 v69, 0xffff0000, v67
    v_add_f32 v34, v34, v68
    v_add_f32 v35, v35, v69
    v_fma_f32 v36, v68, v68, v36
    v_fma_f32 v37, v69, v69, v37
    v_add_u32 v48, 16384, v48
    v_add_u32 v49, 16384, v49
    v_add_u32 v50, 16384, v50
    v_add_u32 v51, 16384, v51
    s_add_u32 s54, s54, 1
    s_cmp_lt_i32 s54, 4
    s_cbranch_scc1 L_k1h_kv_loop
    v_add_f32 v8, v34, v35
    v_add_f32 v9, v36, v37
    s_nop 1
    v_add_f32_dpp v8, v8, v8 quad_perm:[1,0,3,2] row_mask:0xf bank_mask:0xf
    v_add_f32_dpp v9, v9, v9 quad_perm:[1,0,3,2] row_mask:0xf bank_mask:0xf
    s_nop 1
    v_add_f32_dpp v8, v8, v8 quad_perm:[2,3,0,1] row_mask:0xf bank_mask:0xf
    v_add_f32_dpp v9, v9, v9 quad_perm:[2,3,0,1] row_mask:0xf bank_mask:0xf
    v_mul_f32 v8, 0x3b000000, v8
    v_mul_f32 v9, 0x3b000000, v9
    v_fma_f32 v9, -v8, v8, v9
    v_max_f32 v9, 0, v9
    v_add_f32 v9, 0x3727c5ac, v9
    v_rsq_f32 v9, v9
    v_lshlrev_b32 v2, 3, v2
    v_add_u32 v2, 65536, v2
    ds_write_b64 v2, v[8:9]
    s_waitcnt lgkmcnt(0)
    s_barrier
    s_endpgm
L_k1_main_kv:
    v_mov_b32 v48, 0
    v_mov_b32 v49, 0
    v_mov_b32 v50, 0
    v_mov_b32 v51, 0
    v_mov_b32 v52, 0
    v_mov_b32 v53, 0
    v_mov_b32 v54, 0
    v_mov_b32 v55, 0
    v_mov_b32 v56, 0
    v_mov_b32 v57, 0
    v_mov_b32 v58, 0
    v_mov_b32 v59, 0
    v_mov_b32 v60, 0
    v_mov_b32 v61, 0
    v_mov_b32 v62, 0
    v_mov_b32 v63, 0
    v_mov_b32 v64, 0
    v_mov_b32 v65, 0
    v_mov_b32 v66, 0
    v_mov_b32 v67, 0
    v_mov_b32 v68, 0
    v_mov_b32 v69, 0
    v_mov_b32 v70, 0
    v_mov_b32 v71, 0
    v_mov_b32 v72, 0
    v_mov_b32 v73, 0
    v_mov_b32 v74, 0
    v_mov_b32 v75, 0
    v_mov_b32 v76, 0
    v_mov_b32 v77, 0
    v_mov_b32 v78, 0
    v_mov_b32 v79, 0
    v_mov_b32 v80, 0
    v_mov_b32 v81, 0
    v_mov_b32 v82, 0
    v_mov_b32 v83, 0
    v_mov_b32 v84, 0
    v_mov_b32 v85, 0
    v_mov_b32 v86, 0
    v_mov_b32 v87, 0
    v_mov_b32 v88, 0
    v_mov_b32 v89, 0
    v_mov_b32 v90, 0
    v_mov_b32 v91, 0
    v_mov_b32 v92, 0
    v_mov_b32 v93, 0
    v_mov_b32 v94, 0
    v_mov_b32 v95, 0
    v_mov_b32 v96, 0
    v_mov_b32 v97, 0
    v_mov_b32 v98, 0
    v_mov_b32 v99, 0
    v_mov_b32 v100, 0
    v_mov_b32 v101, 0
    v_mov_b32 v102, 0
    v_mov_b32 v103, 0
    v_mov_b32 v104, 0
    v_mov_b32 v105, 0
    v_mov_b32 v106, 0
    v_mov_b32 v107, 0
    v_mov_b32 v108, 0
    v_mov_b32 v109, 0
    v_mov_b32 v110, 0
    v_mov_b32 v111, 0
    s_mov_b32 s54, 4
    s_cmp_lg_u32 s51, 0
    s_cbranch_scc1 L_k1a_1
L_k1m_3:
    s_barrier
    ds_read_b128 v[112:115], v26
    ds_read_b64_tr_b16 v[116:117], v24 offset:0
    ds_read_b64_tr_b16 v[118:119], v24 offset:256
    ds_read_b64_tr_b16 v[120:121], v25 offset:0
    ds_read_b64_tr_b16 v[122:123], v25 offset:256
    ds_read_b128 v[124:127], v27
    ds_read_b64_tr_b16 v[128:129], v24 offset:1024
    ds_read_b64_tr_b16 v[130:131], v24 offset:1280
    ds_read_b64_tr_b16 v[132:133], v25 offset:1024
    ds_read_b64_tr_b16 v[134:135], v25 offset:1280
    ds_read_b128 v[136:139], v28
    ds_read_b64_tr_b16 v[140:141], v24 offset:2048
    ds_read_b64_tr_b16 v[142:143], v24 offset:2304
    ds_read_b64_tr_b16 v[144:145], v25 offset:2048
    ds_read_b64_tr_b16 v[146:147], v25 offset:2304
    s_waitcnt lgkmcnt(10)
    v_mfma_f32_32x32x16_bf16 v[48:63], v[116:119], v[112:115], v[48:63]
    v_mfma_f32_32x32x16_bf16 v[64:79], v[116:119], v[12:15], v[64:79]
    v_mfma_f32_32x32x16_bf16 v[80:95], v[120:123], v[112:115], v[80:95]
    ds_read_b128 v[148:151], v29
    ds_read_b64_tr_b16 v[152:153], v24 offset:3072
    ds_read_b64_tr_b16 v[154:155], v24 offset:3328
    ds_read_b64_tr_b16 v[156:157], v25 offset:3072
    ds_read_b64_tr_b16 v[158:159], v25 offset:3328
    s_waitcnt lgkmcnt(10)
    v_mfma_f32_32x32x16_bf16 v[48:63], v[128:131], v[124:127], v[48:63]
    v_mfma_f32_32x32x16_bf16 v[64:79], v[128:131], v[12:15], v[64:79]
    v_mfma_f32_32x32x16_bf16 v[80:95], v[132:135], v[124:127], v[80:95]
    ds_read_b128 v[160:163], v30
    ds_read_b64_tr_b16 v[164:165], v24 offset:4096
    ds_read_b64_tr_b16 v[166:167], v24 offset:4352
    ds_read_b64_tr_b16 v[168:169], v25 offset:4096
    ds_read_b64_tr_b16 v[170:171], v25 offset:4352
    s_waitcnt lgkmcnt(10)
    v_mfma_f32_32x32x16_bf16 v[48:63], v[140:143], v[136:139], v[48:63]
    v_mfma_f32_32x32x16_bf16 v[64:79], v[140:143], v[12:15], v[64:79]
    v_mfma_f32_32x32x16_bf16 v[80:95], v[144:147], v[136:139], v[80:95]
    ds_read_b128 v[172:175], v31
    ds_read_b64_tr_b16 v[176:177], v24 offset:5120
    ds_read_b64_tr_b16 v[178:179], v24 offset:5376
    ds_read_b64_tr_b16 v[180:181], v25 offset:5120
    ds_read_b64_tr_b16 v[182:183], v25 offset:5376
    s_waitcnt lgkmcnt(10)
    v_mfma_f32_32x32x16_bf16 v[48:63], v[152:155], v[148:151], v[48:63]
    v_mfma_f32_32x32x16_bf16 v[64:79], v[152:155], v[12:15], v[64:79]
    v_mfma_f32_32x32x16_bf16 v[80:95], v[156:159], v[148:151], v[80:95]
    ds_read_b128 v[184:187], v32
    ds_read_b64_tr_b16 v[188:189], v24 offset:6144
    ds_read_b64_tr_b16 v[190:191], v24 offset:6400
    ds_read_b64_tr_b16 v[192:193], v25 offset:6144
    ds_read_b64_tr_b16 v[194:195], v25 offset:6400
    s_waitcnt lgkmcnt(10)
    v_mfma_f32_32x32x16_bf16 v[48:63], v[164:167], v[160:163], v[48:63]
    v_mfma_f32_32x32x16_bf16 v[64:79], v[164:167], v[12:15], v[64:79]
    v_mfma_f32_32x32x16_bf16 v[80:95], v[168:171], v[160:163], v[80:95]
    ds_read_b128 v[196:199], v33
    ds_read_b64_tr_b16 v[200:201], v24 offset:7168
    ds_read_b64_tr_b16 v[202:203], v24 offset:7424
    ds_read_b64_tr_b16 v[204:205], v25 offset:7168
    ds_read_b64_tr_b16 v[206:207], v25 offset:7424
    v_add_u32 v26, 16384, v26
    v_add_u32 v27, 16384, v27
    v_add_u32 v28, 16384, v28
    v_add_u32 v29, 16384, v29
    v_add_u32 v30, 16384, v30
    v_add_u32 v31, 16384, v31
    v_add_u32 v32, 16384, v32
    v_add_u32 v33, 16384, v33
    v_add_u32 v24, 16384, v24
    v_add_u32 v25, 8192, v25
    s_waitcnt lgkmcnt(10)
    v_mfma_f32_32x32x16_bf16 v[48:63], v[176:179], v[172:175], v[48:63]
    v_mfma_f32_32x32x16_bf16 v[64:79], v[176:179], v[12:15], v[64:79]
    v_mfma_f32_32x32x16_bf16 v[80:95], v[180:183], v[172:175], v[80:95]
    s_waitcnt lgkmcnt(5)
    v_mfma_f32_32x32x16_bf16 v[48:63], v[188:191], v[184:187], v[48:63]
    v_mfma_f32_32x32x16_bf16 v[64:79], v[188:191], v[12:15], v[64:79]
    v_mfma_f32_32x32x16_bf16 v[80:95], v[192:195], v[184:187], v[80:95]
    s_waitcnt lgkmcnt(0)
    v_mfma_f32_32x32x16_bf16 v[48:63], v[200:203], v[196:199], v[48:63]
    v_mfma_f32_32x32x16_bf16 v[64:79], v[200:203], v[12:15], v[64:79]
    v_mfma_f32_32x32x16_bf16 v[80:95], v[204:207], v[196:199], v[80:95]
    s_sub_u32 s54, s54, 1
    s_cmp_lg_u32 s54, 0
    s_cbranch_scc1 L_k1m_3
    s_branch L_k1b_2
L_k1a_1:
L_k1m_4:
    s_barrier
    ds_read_b128 v[112:115], v26
    ds_read_b64_tr_b16 v[116:117], v24 offset:0
    ds_read_b64_tr_b16 v[118:119], v24 offset:256
    ds_read_b64_tr_b16 v[120:121], v25 offset:0
    ds_read_b64_tr_b16 v[122:123], v25 offset:256
    ds_read_b128 v[124:127], v27
    ds_read_b64_tr_b16 v[128:129], v24 offset:1024
    ds_read_b64_tr_b16 v[130:131], v24 offset:1280
    ds_read_b64_tr_b16 v[132:133], v25 offset:1024
    ds_read_b64_tr_b16 v[134:135], v25 offset:1280
    ds_read_b128 v[136:139], v28
    ds_read_b64_tr_b16 v[140:141], v24 offset:2048
    ds_read_b64_tr_b16 v[142:143], v24 offset:2304
    ds_read_b64_tr_b16 v[144:145], v25 offset:2048
    ds_read_b64_tr_b16 v[146:147], v25 offset:2304
    s_waitcnt lgkmcnt(10)
    v_mfma_f32_32x32x16_bf16 v[48:63], v[116:119], v[112:115], v[48:63]
    v_mfma_f32_32x32x16_bf16 v[64:79], v[116:119], v[12:15], v[64:79]
    v_mfma_f32_32x32x16_bf16 v[96:111], v[120:123], v[12:15], v[96:111]
    ds_read_b128 v[148:151], v29
    ds_read_b64_tr_b16 v[152:153], v24 offset:3072
    ds_read_b64_tr_b16 v[154:155], v24 offset:3328
    ds_read_b64_tr_b16 v[156:157], v25 offset:3072
    ds_read_b64_tr_b16 v[158:159], v25 offset:3328
    s_waitcnt lgkmcnt(10)
    v_mfma_f32_32x32x16_bf16 v[48:63], v[128:131], v[124:127], v[48:63]
    v_mfma_f32_32x32x16_bf16 v[64:79], v[128:131], v[12:15], v[64:79]
    v_mfma_f32_32x32x16_bf16 v[96:111], v[132:135], v[12:15], v[96:111]
    ds_read_b128 v[160:163], v30
    ds_read_b64_tr_b16 v[164:165], v24 offset:4096
    ds_read_b64_tr_b16 v[166:167], v24 offset:4352
    ds_read_b64_tr_b16 v[168:169], v25 offset:4096
    ds_read_b64_tr_b16 v[170:171], v25 offset:4352
    s_waitcnt lgkmcnt(10)
    v_mfma_f32_32x32x16_bf16 v[48:63], v[140:143], v[136:139], v[48:63]
    v_mfma_f32_32x32x16_bf16 v[64:79], v[140:143], v[12:15], v[64:79]
    v_mfma_f32_32x32x16_bf16 v[96:111], v[144:147], v[12:15], v[96:111]
    ds_read_b128 v[172:175], v31
    ds_read_b64_tr_b16 v[176:177], v24 offset:5120
    ds_read_b64_tr_b16 v[178:179], v24 offset:5376
    ds_read_b64_tr_b16 v[180:181], v25 offset:5120
    ds_read_b64_tr_b16 v[182:183], v25 offset:5376
    s_waitcnt lgkmcnt(10)
    v_mfma_f32_32x32x16_bf16 v[48:63], v[152:155], v[148:151], v[48:63]
    v_mfma_f32_32x32x16_bf16 v[64:79], v[152:155], v[12:15], v[64:79]
    v_mfma_f32_32x32x16_bf16 v[96:111], v[156:159], v[12:15], v[96:111]
    ds_read_b128 v[184:187], v32
    ds_read_b64_tr_b16 v[188:189], v24 offset:6144
    ds_read_b64_tr_b16 v[190:191], v24 offset:6400
    ds_read_b64_tr_b16 v[192:193], v25 offset:6144
    ds_read_b64_tr_b16 v[194:195], v25 offset:6400
    s_waitcnt lgkmcnt(10)
    v_mfma_f32_32x32x16_bf16 v[48:63], v[164:167], v[160:163], v[48:63]
    v_mfma_f32_32x32x16_bf16 v[64:79], v[164:167], v[12:15], v[64:79]
    v_mfma_f32_32x32x16_bf16 v[96:111], v[168:171], v[12:15], v[96:111]
    ds_read_b128 v[196:199], v33
    ds_read_b64_tr_b16 v[200:201], v24 offset:7168
    ds_read_b64_tr_b16 v[202:203], v24 offset:7424
    ds_read_b64_tr_b16 v[204:205], v25 offset:7168
    ds_read_b64_tr_b16 v[206:207], v25 offset:7424
    v_add_u32 v26, 16384, v26
    v_add_u32 v27, 16384, v27
    v_add_u32 v28, 16384, v28
    v_add_u32 v29, 16384, v29
    v_add_u32 v30, 16384, v30
    v_add_u32 v31, 16384, v31
    v_add_u32 v32, 16384, v32
    v_add_u32 v33, 16384, v33
    v_add_u32 v24, 16384, v24
    v_add_u32 v25, 8192, v25
    s_waitcnt lgkmcnt(10)
    v_mfma_f32_32x32x16_bf16 v[48:63], v[176:179], v[172:175], v[48:63]
    v_mfma_f32_32x32x16_bf16 v[64:79], v[176:179], v[12:15], v[64:79]
    v_mfma_f32_32x32x16_bf16 v[96:111], v[180:183], v[12:15], v[96:111]
    s_waitcnt lgkmcnt(5)
    v_mfma_f32_32x32x16_bf16 v[48:63], v[188:191], v[184:187], v[48:63]
    v_mfma_f32_32x32x16_bf16 v[64:79], v[188:191], v[12:15], v[64:79]
    v_mfma_f32_32x32x16_bf16 v[96:111], v[192:195], v[12:15], v[96:111]
    s_waitcnt lgkmcnt(0)
    v_mfma_f32_32x32x16_bf16 v[48:63], v[200:203], v[196:199], v[48:63]
    v_mfma_f32_32x32x16_bf16 v[64:79], v[200:203], v[12:15], v[64:79]
    v_mfma_f32_32x32x16_bf16 v[96:111], v[204:207], v[12:15], v[96:111]
    s_sub_u32 s54, s54, 1
    s_cmp_lg_u32 s54, 0
    s_cbranch_scc1 L_k1m_4
L_k1b_2:
    s_lshl_b32 s5, s50, 12
    s_add_u32 s5, s5, 69632
    v_lshl_add_u32 v2, v1, 4, s5
    s_cmp_eq_u32 s51, 0
    s_cbranch_scc1 L_k1w_5
    s_nop 15
    s_nop 7
    ds_write_b128 v2, v[96:99] offset:0
    ds_write_b128 v2, v[100:103] offset:1024
    ds_write_b128 v2, v[104:107] offset:2048
    ds_write_b128 v2, v[108:111] offset:3072
    s_waitcnt lgkmcnt(0)
L_k1w_5:
    v_and_b32 v3, 31, v1
    s_lshl_b32 s5, s50, 8
    s_add_u32 s5, s5, 65536
    v_lshl_add_u32 v3, v3, 3, s5
    s_barrier
    ds_read_b64 v[8:9], v3
    ds_read_b128 v[96:99], v2 offset:0
    ds_read_b128 v[100:103], v2 offset:1024
    ds_read_b128 v[104:107], v2 offset:2048
    ds_read_b128 v[108:111], v2 offset:3072
    s_nop 7
    s_waitcnt lgkmcnt(0)
    v_mul_f32 v11, 0x3eb8aa3b, v9
    v_fma_f32 v48, -v8, v64, v48
    v_fma_f32 v49, -v8, v65, v49
    v_fma_f32 v50, -v8, v66, v50
    v_fma_f32 v51, -v8, v67, v51
    v_fma_f32 v52, -v8, v68, v52
    v_fma_f32 v53, -v8, v69, v53
    v_fma_f32 v54, -v8, v70, v54
    v_fma_f32 v55, -v8, v71, v55
    v_fma_f32 v56, -v8, v72, v56
    v_fma_f32 v57, -v8, v73, v57
    v_fma_f32 v58, -v8, v74, v58
    v_fma_f32 v59, -v8, v75, v59
    v_fma_f32 v60, -v8, v76, v60
    v_fma_f32 v61, -v8, v77, v61
    v_fma_f32 v62, -v8, v78, v62
    v_fma_f32 v63, -v8, v79, v63
    v_mul_f32 v48, v11, v48
    v_mul_f32 v49, v11, v49
    v_mul_f32 v50, v11, v50
    v_mul_f32 v51, v11, v51
    v_mul_f32 v52, v11, v52
    v_mul_f32 v53, v11, v53
    v_mul_f32 v54, v11, v54
    v_mul_f32 v55, v11, v55
    v_mul_f32 v56, v11, v56
    v_mul_f32 v57, v11, v57
    v_mul_f32 v58, v11, v58
    v_mul_f32 v59, v11, v59
    v_mul_f32 v60, v11, v60
    v_mul_f32 v61, v11, v61
    v_mul_f32 v62, v11, v62
    v_mul_f32 v63, v11, v63
    v_cvt_pk_bf16_f32 v64, v48, v49
    v_cvt_pk_bf16_f32 v65, v50, v51
    v_cvt_pk_bf16_f32 v66, v52, v53
    v_cvt_pk_bf16_f32 v67, v54, v55
    v_cvt_pk_bf16_f32 v68, v56, v57
    v_cvt_pk_bf16_f32 v69, v58, v59
    v_cvt_pk_bf16_f32 v70, v60, v61
    v_cvt_pk_bf16_f32 v71, v62, v63
    v_and_b32 v2, 31, v1
    v_lshrrev_b32 v3, 5, v1
    v_lshlrev_b32 v4, 10, v2
    v_lshl_add_u32 v4, v3, 3, v4
    s_lshl_b32 s5, s50, 5
    s_add_u32 s5, s5, s46
    s_lshl_b32 s7, s5, 10
    s_lshl_b32 s6, s4, 7
    s_add_u32 s7, s7, s6
    s_lshl_b32 s6, s51, 6
    s_add_u32 s7, s7, s6
    s_add_u32 s7, s7, 0
    s_add_u32 s56, s30, s7
    s_addc_u32 s57, s31, 0
    v_lshl_add_u32 v5, v3, 3, v4
    v_permlane32_swap_b32 v64, v66
    v_permlane32_swap_b32 v65, v67
    v_permlane32_swap_b32 v68, v70
    v_permlane32_swap_b32 v69, v71
    s_nop 1
    global_store_dwordx4 v5, v[64:67], s[56:57] offset:0
    global_store_dwordx4 v5, v[68:71], s[56:57] offset:32
    s_cmp_lg_u32 s51, 0
    s_cbranch_scc1 L_k1_exit
    v_fma_f32 v80, -v8, v96, v80
    v_fma_f32 v81, -v8, v97, v81
    v_fma_f32 v82, -v8, v98, v82
    v_fma_f32 v83, -v8, v99, v83
    v_fma_f32 v84, -v8, v100, v84
    v_fma_f32 v85, -v8, v101, v85
    v_fma_f32 v86, -v8, v102, v86
    v_fma_f32 v87, -v8, v103, v87
    v_fma_f32 v88, -v8, v104, v88
    v_fma_f32 v89, -v8, v105, v89
    v_fma_f32 v90, -v8, v106, v90
    v_fma_f32 v91, -v8, v107, v91
    v_fma_f32 v92, -v8, v108, v92
    v_fma_f32 v93, -v8, v109, v93
    v_fma_f32 v94, -v8, v110, v94
    v_fma_f32 v95, -v8, v111, v95
    v_mul_f32 v80, v9, v80
    v_mul_f32 v81, v9, v81
    v_mul_f32 v82, v9, v82
    v_mul_f32 v83, v9, v83
    v_mul_f32 v84, v9, v84
    v_mul_f32 v85, v9, v85
    v_mul_f32 v86, v9, v86
    v_mul_f32 v87, v9, v87
    v_mul_f32 v88, v9, v88
    v_mul_f32 v89, v9, v89
    v_mul_f32 v90, v9, v90
    v_mul_f32 v91, v9, v91
    v_mul_f32 v92, v9, v92
    v_mul_f32 v93, v9, v93
    v_mul_f32 v94, v9, v94
    v_mul_f32 v95, v9, v95
    v_cvt_pk_bf16_f32 v96, v80, v81
    v_cvt_pk_bf16_f32 v97, v82, v83
    v_cvt_pk_bf16_f32 v98, v84, v85
    v_cvt_pk_bf16_f32 v99, v86, v87
    v_cvt_pk_bf16_f32 v100, v88, v89
    v_cvt_pk_bf16_f32 v101, v90, v91
    v_cvt_pk_bf16_f32 v102, v92, v93
    v_cvt_pk_bf16_f32 v103, v94, v95
    v_lshlrev_b32 v4, 4, v2
    v_lshl_add_u32 v4, v3, 3, v4
    s_lshr_b32 s5, s5, 5
    s_lshl_b32 s5, s5, 10
    s_add_u32 s6, s5, 2097152
    s_add_u32 s56, s30, s6
    s_addc_u32 s57, s31, 0
    global_store_dwordx2 v4, v[96:97], s[56:57]
    global_store_dwordx2 v4, v[98:99], s[56:57] offset:512
    v_lshrrev_b32 v5, 4, v2
    v_lshlrev_b32 v5, 9, v5
    v_bfe_u32 v6, v2, 2, 1
    v_lshl_add_u32 v5, v6, 8, v5
    v_bfe_u32 v6, v2, 3, 1
    v_lshl_add_u32 v5, v6, 3, v5
    v_and_b32 v6, 3, v2
    v_lshl_add_u32 v5, v6, 1, v5
    v_lshl_add_u32 v5, v3, 6, v5
    s_add_u32 s6, s5, 2162688
    s_add_u32 s56, s30, s6
    s_addc_u32 s57, s31, 0
    global_store_short v5, v100, s[56:57] offset:0
    global_store_short_d16_hi v5, v100, s[56:57] offset:16
    global_store_short v5, v101, s[56:57] offset:32
    global_store_short_d16_hi v5, v101, s[56:57] offset:48
    global_store_short v5, v102, s[56:57] offset:128
    global_store_short_d16_hi v5, v102, s[56:57] offset:144
    global_store_short v5, v103, s[56:57] offset:160
    global_store_short_d16_hi v5, v103, s[56:57] offset:176
    s_endpgm
L_k1_q:
    s_cmp_eq_u32 s53, 0
    s_cbranch_scc1 L_k1_main_q
    s_mov_b32 s55, s52
    s_add_u32 s58, s52, 131072
    s_mov_b32 s54, -2
L_k1h_q_loop:
    s_cmp_lt_i32 s54, 0
    s_cbranch_scc1 L_k1h_q_iss
    s_waitcnt vmcnt(8)
    s_cmp_lg_u32 s54, 3
    s_cbranch_scc1 L_k1h_q_nw
    s_waitcnt vmcnt(0)
L_k1h_q_nw:
    s_barrier
    ds_read_b128 v[52:55], v48
    ds_read_b128 v[56:59], v49
    ds_read_b128 v[60:63], v50
    ds_read_b128 v[64:67], v51
    s_cmp_ge_i32 s54, 2
    s_cbranch_scc1 L_k1h_q_st
L_k1h_q_iss:
    s_add_u32 m0, s55, 0
    s_nop 0
    global_load_lds_dwordx4 v16, s[40:41]
    s_add_u32 m0, s55, 4096
    s_nop 0
    global_load_lds_dwordx4 v17, s[40:41]
    s_add_u32 m0, s55, 8192
    s_nop 0
    global_load_lds_dwordx4 v18, s[40:41]
    s_add_u32 m0, s55, 12288
    s_nop 0
    global_load_lds_dwordx4 v19, s[40:41]
    s_add_u32 m0, s55, 65536
    s_nop 0
    global_load_lds_dwordx4 v20, s[42:43]
    s_add_u32 m0, s55, 69632
    s_nop 0
    global_load_lds_dwordx4 v21, s[42:43]
    s_add_u32 m0, s55, 73664
    s_nop 0
    global_load_lds_dwordx4 v20, s[42:43] offset:64
    s_add_u32 m0, s55, 77760
    s_nop 0
    global_load_lds_dwordx4 v21, s[42:43] offset:64
    s_add_u32 s40, s40, 256
    s_addc_u32 s41, s41, 0
    s_add_u32 s42, s42, 131072
    s_addc_u32 s43, s43, 0
    s_add_u32 s55, s55, 16384
    s_cmp_ge_i32 s54, 0
    s_cbranch_scc1 L_k1h_q_st
    s_add_u32 s54, s54, 1
    s_cmp_lt_i32 s54, 0
    s_cbranch_scc1 L_k1h_q_iss
    v_lshrrev_b32 v2, 2, v1
    s_lshl_b32 s5, s48, 4
    v_add_u32 v2, s5, v2
    v_and_b32 v3, 3, v1
    v_and_b32 v4, 3, v2
    v_lshl_add_u32 v3, v4, 2, v3
    v_add_u32 v4, 0, v3
    v_and_b32 v4, 15, v4
    v_lshlrev_b32 v4, 4, v4
    v_lshl_add_u32 v48, v2, 8, v4
    v_add_u32 v4, 4, v3
    v_and_b32 v4, 15, v4
    v_lshlrev_b32 v4, 4, v4
    v_lshl_add_u32 v49, v2, 8, v4
    v_add_u32 v4, 8, v3
    v_and_b32 v4, 15, v4
    v_lshlrev_b32 v4, 4, v4
    v_lshl_add_u32 v50, v2, 8, v4
    v_add_u32 v4, 12, v3
    v_and_b32 v4, 15, v4
    v_lshlrev_b32 v4, 4, v4
    v_lshl_add_u32 v51, v2, 8, v4
    s_branch L_k1h_q_loop
L_k1h_q_st:
    s_waitcnt lgkmcnt(3)
    v_lshlrev_b32 v68, 16, v52
    v_and_b32 v69, 0xffff0000, v52
    v_add_f32 v34, v34, v68
    v_add_f32 v35, v35, v69
    v_fma_f32 v36, v68, v68, v36
    v_fma_f32 v37, v69, v69, v37
    v_lshlrev_b32 v68, 16, v53
    v_and_b32 v69, 0xffff0000, v53
    v_add_f32 v34, v34, v68
    v_add_f32 v35, v35, v69
    v_fma_f32 v36, v68, v68, v36
    v_fma_f32 v37, v69, v69, v37
    v_lshlrev_b32 v68, 16, v54
    v_and_b32 v69, 0xffff0000, v54
    v_add_f32 v34, v34, v68
    v_add_f32 v35, v35, v69
    v_fma_f32 v36, v68, v68, v36
    v_fma_f32 v37, v69, v69, v37
    v_lshlrev_b32 v68, 16, v55
    v_and_b32 v69, 0xffff0000, v55
    v_add_f32 v34, v34, v68
    v_add_f32 v35, v35, v69
    v_fma_f32 v36, v68, v68, v36
    v_fma_f32 v37, v69, v69, v37
    s_waitcnt lgkmcnt(2)
    v_lshlrev_b32 v68, 16, v56
    v_and_b32 v69, 0xffff0000, v56
    v_add_f32 v34, v34, v68
    v_add_f32 v35, v35, v69
    v_fma_f32 v36, v68, v68, v36
    v_fma_f32 v37, v69, v69, v37
    v_lshlrev_b32 v68, 16, v57
    v_and_b32 v69, 0xffff0000, v57
    v_add_f32 v34, v34, v68
    v_add_f32 v35, v35, v69
    v_fma_f32 v36, v68, v68, v36
    v_fma_f32 v37, v69, v69, v37
    v_lshlrev_b32 v68, 16, v58
    v_and_b32 v69, 0xffff0000, v58
    v_add_f32 v34, v34, v68
    v_add_f32 v35, v35, v69
    v_fma_f32 v36, v68, v68, v36
    v_fma_f32 v37, v69, v69, v37
    v_lshlrev_b32 v68, 16, v59
    v_and_b32 v69, 0xffff0000, v59
    v_add_f32 v34, v34, v68
    v_add_f32 v35, v35, v69
    v_fma_f32 v36, v68, v68, v36
    v_fma_f32 v37, v69, v69, v37
    s_waitcnt lgkmcnt(1)
    v_lshlrev_b32 v68, 16, v60
    v_and_b32 v69, 0xffff0000, v60
    v_add_f32 v34, v34, v68
    v_add_f32 v35, v35, v69
    v_fma_f32 v36, v68, v68, v36
    v_fma_f32 v37, v69, v69, v37
    v_lshlrev_b32 v68, 16, v61
    v_and_b32 v69, 0xffff0000, v61
    v_add_f32 v34, v34, v68
    v_add_f32 v35, v35, v69
    v_fma_f32 v36, v68, v68, v36
    v_fma_f32 v37, v69, v69, v37
    v_lshlrev_b32 v68, 16, v62
    v_and_b32 v69, 0xffff0000, v62
    v_add_f32 v34, v34, v68
    v_add_f32 v35, v35, v69
    v_fma_f32 v36, v68, v68, v36
    v_fma_f32 v37, v69, v69, v37
    v_lshlrev_b32 v68, 16, v63
    v_and_b32 v69, 0xffff0000, v63
    v_add_f32 v34, v34, v68
    v_add_f32 v35, v35, v69
    v_fma_f32 v36, v68, v68, v36
    v_fma_f32 v37, v69, v69, v37
    s_waitcnt lgkmcnt(0)
    v_lshlrev_b32 v68, 16, v64
    v_and_b32 v69, 0xffff0000, v64
    v_add_f32 v34, v34, v68
    v_add_f32 v35, v35, v69
    v_fma_f32 v36, v68, v68, v36
    v_fma_f32 v37, v69, v69, v37
    v_lshlrev_b32 v68, 16, v65
    v_and_b32 v69, 0xffff0000, v65
    v_add_f32 v34, v34, v68
    v_add_f32 v35, v35, v69
    v_fma_f32 v36, v68, v68, v36
    v_fma_f32 v37, v69, v69, v37
    v_lshlrev_b32 v68, 16, v66
    v_and_b32 v69, 0xffff0000, v66
    v_add_f32 v34, v34, v68
    v_add_f32 v35, v35, v69
    v_fma_f32 v36, v68, v68, v36
    v_fma_f32 v37, v69, v69, v37
    v_lshlrev_b32 v68, 16, v67
    v_and_b32 v69, 0xffff0000, v67
    v_add_f32 v34, v34, v68
    v_add_f32 v35, v35, v69
    v_fma_f32 v36, v68, v68, v36
    v_fma_f32 v37, v69, v69, v37
    v_add_u32 v48, 16384, v48
    v_add_u32 v49, 16384, v49
    v_add_u32 v50, 16384, v50
    v_add_u32 v51, 16384, v51
    s_add_u32 s54, s54, 1
    s_cmp_lt_i32 s54, 4
    s_cbranch_scc1 L_k1h_q_loop
    v_add_f32 v8, v34, v35
    v_add_f32 v9, v36, v37
    s_nop 1
    v_add_f32_dpp v8, v8, v8 quad_perm:[1,0,3,2] row_mask:0xf bank_mask:0xf
    v_add_f32_dpp v9, v9, v9 quad_perm:[1,0,3,2] row_mask:0xf bank_mask:0xf
    s_nop 1
    v_add_f32_dpp v8, v8, v8 quad_perm:[2,3,0,1] row_mask:0xf bank_mask:0xf
    v_add_f32_dpp v9, v9, v9 quad_perm:[2,3,0,1] row_mask:0xf bank_mask:0xf
    v_mul_f32 v8, 0x3b000000, v8
    v_mul_f32 v9, 0x3b000000, v9
    v_fma_f32 v9, -v8, v8, v9
    v_max_f32 v9, 0, v9
    v_add_f32 v9, 0x3727c5ac, v9
    v_rsq_f32 v9, v9
    v_lshlrev_b32 v2, 3, v2
    v_add_u32 v2, 65536, v2
    ds_write_b64 v2, v[8:9]
    s_waitcnt lgkmcnt(0)
    s_barrier
    s_endpgm
L_k1_main_q:
    v_mov_b32 v48, 0
    v_mov_b32 v49, 0
    v_mov_b32 v50, 0
    v_mov_b32 v51, 0
    v_mov_b32 v52, 0
    v_mov_b32 v53, 0
    v_mov_b32 v54, 0
    v_mov_b32 v55, 0
    v_mov_b32 v56, 0
    v_mov_b32 v57, 0
    v_mov_b32 v58, 0
    v_mov_b32 v59, 0
    v_mov_b32 v60, 0
    v_mov_b32 v61, 0
    v_mov_b32 v62, 0
    v_mov_b32 v63, 0
    v_mov_b32 v64, 0
    v_mov_b32 v65, 0
    v_mov_b32 v66, 0
    v_mov_b32 v67, 0
    v_mov_b32 v68, 0
    v_mov_b32 v69, 0
    v_mov_b32 v70, 0
    v_mov_b32 v71, 0
    v_mov_b32 v72, 0
    v_mov_b32 v73, 0
    v_mov_b32 v74, 0
    v_mov_b32 v75, 0
    v_mov_b32 v76, 0
    v_mov_b32 v77, 0
    v_mov_b32 v78, 0
    v_mov_b32 v79, 0
    s_mov_b32 s54, 4
L_k1m_6:
    s_barrier
    ds_read_b128 v[112:115], v26
    ds_read_b64_tr_b16 v[116:117], v24 offset:0
    ds_read_b64_tr_b16 v[118:119], v24 offset:256
    ds_read_b128 v[124:127], v27
    ds_read_b64_tr_b16 v[128:129], v24 offset:1024
    ds_read_b64_tr_b16 v[130:131], v24 offset:1280
    ds_read_b128 v[136:139], v28
    ds_read_b64_tr_b16 v[140:141], v24 offset:2048
    ds_read_b64_tr_b16 v[142:143], v24 offset:2304
    ds_read_b128 v[148:151], v29
    ds_read_b64_tr_b16 v[152:153], v24 offset:3072
    ds_read_b64_tr_b16 v[154:155], v24 offset:3328
    ds_read_b128 v[160:163], v30
    ds_read_b64_tr_b16 v[164:165], v24 offset:4096
    ds_read_b64_tr_b16 v[166:167], v24 offset:4352
    s_waitcnt lgkmcnt(12)
    v_mfma_f32_32x32x16_bf16 v[48:63], v[116:119], v[112:115], v[48:63]
    v_mfma_f32_32x32x16_bf16 v[64:79], v[116:119], v[12:15], v[64:79]
    ds_read_b128 v[172:175], v31
    ds_read_b64_tr_b16 v[176:177], v24 offset:5120
    ds_read_b64_tr_b16 v[178:179], v24 offset:5376
    s_waitcnt lgkmcnt(12)
    v_mfma_f32_32x32x16_bf16 v[48:63], v[128:131], v[124:127], v[48:63]
    v_mfma_f32_32x32x16_bf16 v[64:79], v[128:131], v[12:15], v[64:79]
    ds_read_b128 v[184:187], v32
    ds_read_b64_tr_b16 v[188:189], v24 offset:6144
    ds_read_b64_tr_b16 v[190:191], v24 offset:6400
    s_waitcnt lgkmcnt(12)
    v_mfma_f32_32x32x16_bf16 v[48:63], v[140:143], v[136:139], v[48:63]
    v_mfma_f32_32x32x16_bf16 v[64:79], v[140:143], v[12:15], v[64:79]
    ds_read_b128 v[196:199], v33
    ds_read_b64_tr_b16 v[200:201], v24 offset:7168
    ds_read_b64_tr_b16 v[202:203], v24 offset:7424
    v_add_u32 v26, 16384, v26
    v_add_u32 v27, 16384, v27
    v_add_u32 v28, 16384, v28
    v_add_u32 v29, 16384, v29
    v_add_u32 v30, 16384, v30
    v_add_u32 v31, 16384, v31
    v_add_u32 v32, 16384, v32
    v_add_u32 v33, 16384, v33
    v_add_u32 v24, 16384, v24
    s_waitcnt lgkmcnt(12)
    v_mfma_f32_32x32x16_bf16 v[48:63], v[152:155], v[148:151], v[48:63]
    v_mfma_f32_32x32x16_bf16 v[64:79], v[152:155], v[12:15], v[64:79]
    s_waitcnt lgkmcnt(9)
    v_mfma_f32_32x32x16_bf16 v[48:63], v[164:167], v[160:163], v[48:63]
    v_mfma_f32_32x32x16_bf16 v[64:79], v[164:167], v[12:15], v[64:79]
    s_waitcnt lgkmcnt(6)
    v_mfma_f32_32x32x16_bf16 v[48:63], v[176:179], v[172:175], v[48:63]
    v_mfma_f32_32x32x16_bf16 v[64:79], v[176:179], v[12:15], v[64:79]
    s_waitcnt lgkmcnt(3)
    v_mfma_f32_32x32x16_bf16 v[48:63], v[188:191], v[184:187], v[48:63]
    v_mfma_f32_32x32x16_bf16 v[64:79], v[188:191], v[12:15], v[64:79]
    s_waitcnt lgkmcnt(0)
    v_mfma_f32_32x32x16_bf16 v[48:63], v[200:203], v[196:199], v[48:63]
    v_mfma_f32_32x32x16_bf16 v[64:79], v[200:203], v[12:15], v[64:79]
    s_sub_u32 s54, s54, 1
    s_cmp_lg_u32 s54, 0
    s_cbranch_scc1 L_k1m_6
    v_and_b32 v3, 31, v1
    s_lshl_b32 s5, s50, 8
    s_add_u32 s5, s5, 65536
    v_lshl_add_u32 v3, v3, 3, s5
    s_barrier
    ds_read_b64 v[8:9], v3
    s_nop 7
    s_waitcnt lgkmcnt(0)
    v_mul_f32 v11, 0x3eb8aa3b, v9
    v_fma_f32 v48, -v8, v64, v48
    v_fma_f32 v49, -v8, v65, v49
    v_fma_f32 v50, -v8, v66, v50
    v_fma_f32 v51, -v8, v67, v51
    v_fma_f32 v52, -v8, v68, v52
    v_fma_f32 v53, -v8, v69, v53
    v_fma_f32 v54, -v8, v70, v54
    v_fma_f32 v55, -v8, v71, v55
    v_fma_f32 v56, -v8, v72, v56
    v_fma_f32 v57, -v8, v73, v57
    v_fma_f32 v58, -v8, v74, v58
    v_fma_f32 v59, -v8, v75, v59
    v_fma_f32 v60, -v8, v76, v60
    v_fma_f32 v61, -v8, v77, v61
    v_fma_f32 v62, -v8, v78, v62
    v_fma_f32 v63, -v8, v79, v63
    v_mul_f32 v48, v11, v48
    v_mul_f32 v49, v11, v49
    v_mul_f32 v50, v11, v50
    v_mul_f32 v51, v11, v51
    v_mul_f32 v52, v11, v52
    v_mul_f32 v53, v11, v53
    v_mul_f32 v54, v11, v54
    v_mul_f32 v55, v11, v55
    v_mul_f32 v56, v11, v56
    v_mul_f32 v57, v11, v57
    v_mul_f32 v58, v11, v58
    v_mul_f32 v59, v11, v59
    v_mul_f32 v60, v11, v60
    v_mul_f32 v61, v11, v61
    v_mul_f32 v62, v11, v62
    v_mul_f32 v63, v11, v63
    v_cvt_pk_bf16_f32 v64, v48, v49
    v_cvt_pk_bf16_f32 v65, v50, v51
    v_cvt_pk_bf16_f32 v66, v52, v53
    v_cvt_pk_bf16_f32 v67, v54, v55
    v_cvt_pk_bf16_f32 v68, v56, v57
    v_cvt_pk_bf16_f32 v69, v58, v59
    v_cvt_pk_bf16_f32 v70, v60, v61
    v_cvt_pk_bf16_f32 v71, v62, v63
    v_and_b32 v2, 31, v1
    v_lshrrev_b32 v3, 5, v1
    v_lshlrev_b32 v4, 10, v2
    v_lshl_add_u32 v4, v3, 3, v4
    s_lshl_b32 s5, s50, 5
    s_add_u32 s5, s5, s46
    s_lshl_b32 s7, s5, 10
    s_lshl_b32 s6, s4, 7
    s_add_u32 s7, s7, s6
    s_lshl_b32 s6, s51, 6
    s_add_u32 s7, s7, s6
    s_add_u32 s7, s7, 0
    s_add_u32 s56, s30, s7
    s_addc_u32 s57, s31, 0
    v_lshl_add_u32 v5, v3, 3, v4
    v_permlane32_swap_b32 v64, v66
    v_permlane32_swap_b32 v65, v67
    v_permlane32_swap_b32 v68, v70
    v_permlane32_swap_b32 v69, v71
    s_nop 1
    global_store_dwordx4 v5, v[64:67], s[56:57] offset:0
    global_store_dwordx4 v5, v[68:71], s[56:57] offset:32
    s_endpgm
L_k1_exit:
    s_endpgm

.globl k2_attn_kernel
.p2align 8
.type k2_attn_kernel,@function
k2_attn_kernel:
    s_load_dwordx16 s[8:23], s[0:1], 0
    s_load_dwordx8 s[24:31], s[0:1], 64
    s_cmp_ge_u32 s2, 256
    s_cbranch_scc1 L_k2_exit
    v_and_b32 v1, 63, v0
    v_lshrrev_b32 v2, 6, v0
    s_nop 0
    v_readfirstlane_b32 s3, v2
    s_lshr_b32 s4, s3, 1
    s_lshl_b32 s5, s2, 3
    s_add_u32 s4, s4, s5
    s_and_b32 s6, s3, 1
    v_lshlrev_b32 v3, 4, v1
    s_waitcnt lgkmcnt(0)
    s_lshr_b32 s7, s3, 2
    s_lshl_b32 s7, s7, 15
    s_mov_b32 s66, s7
    s_and_b32 s48, s3, 3
    s_lshl_b32 s49, s48, 11
    s_add_u32 s49, s49, s7
    s_add_u32 s50, s49, 2097152
    s_add_u32 s40, s30, s50
    s_addc_u32 s41, s31, 0
    s_mov_b32 m0, s49
    s_nop 0
    global_load_lds_dwordx4 v3, s[40:41]
    global_load_lds_dwordx4 v3, s[40:41] offset:1024
    s_lshl_b32 s5, s4, 10
    s_add_u32 s50, s5, 0
    s_add_u32 s42, s30, s50
    s_addc_u32 s43, s31, 0
    v_and_b32 v2, 31, v1
    v_lshrrev_b32 v114, 5, v1
    v_lshlrev_b32 v115, 5, v2
    v_lshl_add_u32 v115, v114, 4, v115
    global_load_dwordx4 v[4:7], v115, s[42:43]
    s_mov_b32 s62, 0
    s_cmp_eq_u32 s6, 0
    s_cbranch_scc1 L_k2_nopp
    s_lshr_b32 s50, s3, 1
    s_lshl_b32 s51, s50, 8
    s_add_u32 s51, s51, s2
    s_cmp_ge_u32 s51, 1168
    s_cbranch_scc1 L_k2_nopp
    s_mov_b32 s62, 4
    s_mov_b32 s63, 0
    s_cmp_lt_u32 s51, 128
    s_cbranch_scc1 L_k2_ppwo
    s_cmp_lt_u32 s51, 816
    s_cbranch_scc1 L_k2_ppgu
    s_sub_u32 s51, s51, 816
    s_mul_i32 s52, s51, 2979
    s_lshr_b32 s52, s52, 16
    s_mul_i32 s53, s52, 22
    s_sub_u32 s53, s51, s53
    s_cmp_eq_u32 s53, 21
    s_cselect_b32 s62, 2, 4
    s_mul_i32 s54, s52, 88064
    s_lshl_b32 s55, s53, 12
    s_add_u32 s54, s54, s55
    s_add_u32 s54, s54, 22020096
    s_add_u32 s60, s30, s54
    s_addc_u32 s61, s31, 0
    s_lshl_b32 s54, s53, 16
    s_lshl_b32 s55, s52, 6
    s_add_u32 s54, s54, s55
    s_add_u32 s58, s24, s54
    s_addc_u32 s59, s25, 0
    s_mov_b32 s57, 1024
    s_branch L_k2_ppgo
L_k2_ppwo:
    s_lshr_b32 s52, s51, 3
    s_and_b32 s53, s51, 7
    s_lshl_b32 s54, s52, 15
    s_lshl_b32 s55, s53, 12
    s_add_u32 s54, s54, s55
    s_add_u32 s54, s54, 16777216
    s_add_u32 s60, s30, s54
    s_addc_u32 s61, s31, 0
    s_lshl_b32 s54, s53, 16
    s_lshl_b32 s55, s52, 6
    s_add_u32 s54, s54, s55
    s_add_u32 s58, s16, s54
    s_addc_u32 s59, s17, 0
    s_mov_b32 s57, 1024
    s_branch L_k2_ppgo
L_k2_ppgu:
    s_sub_u32 s51, s51, 128
    s_mov_b32 s58, s20
    s_mov_b32 s59, s21
    s_mov_b32 s56, 17825792
    s_mov_b32 s63, 0
    s_cmp_lt_u32 s51, 344
    s_cbranch_scc1 L_k2_ppg
    s_sub_u32 s51, s51, 344
    s_mov_b32 s58, s22
    s_mov_b32 s59, s23
    s_mov_b32 s56, 19922944
    s_mov_b32 s63, 1
L_k2_ppg:
    s_lshr_b32 s52, s51, 3
    s_and_b32 s53, s51, 7
    s_lshl_b32 s54, s52, 15
    s_lshl_b32 s55, s53, 12
    s_add_u32 s54, s54, s55
    s_add_u32 s54, s54, s56
    s_add_u32 s60, s30, s54
    s_addc_u32 s61, s31, 0
    s_mul_i32 s54, s53, 176128
    s_lshl_b32 s55, s52, 6
    s_add_u32 s54, s54, s55
    s_add_u32 s58, s58, s54
    s_addc_u32 s59, s59, 0
    s_lshl_b32 s54, s53, 1
    s_add_u32 s54, s54, s63
    s_mul_i32 s54, s54, 5504
    s_lshl_b32 s55, s52, 7
    s_add_u32 s54, s54, s55
    s_add_u32 s54, s54, 9437184
    s_add_u32 s64, s30, s54
    s_addc_u32 s65, s31, 0
    s_mov_b32 s63, 1
    s_mov_b32 s57, 2752
    s_branch L_k2_ppgo2
L_k2_ppgo:
    s_mov_b32 s63, 0
L_k2_ppgo2:
    v_lshrrev_b32 v114, 2, v1
    v_mul_lo_u32 v114, v114, s57
    v_and_b32 v115, 3, v1
    v_lshl_add_u32 v120, v115, 4, v114
L_k2_nopp:
    s_lshl_b32 s7, s6, 15
    v_lshlrev_b32 v112, 4, v1
    v_add_u32 v112, s7, v112
    v_lshrrev_b32 v114, 5, v1
    v_and_b32 v115, 15, v1
    v_lshlrev_b32 v113, 8, v114
    v_lshl_add_u32 v113, v115, 4, v113
    v_add_u32 v113, s7, v113
    v_add_u32 v113, 0x10000, v113
    v_and_b32 v114, 31, v1
    v_cmp_eq_u32 vcc, 16, v114
    v_mov_b32 v115, 0x3f803f80
    v_cndmask_b32 v115, 0, v115, vcc
    v_mov_b32 v96, v115
    v_mov_b32 v97, v115
    v_mov_b32 v98, v115
    v_mov_b32 v99, v115
    v_mov_b32 v100, v115
    v_mov_b32 v101, v115
    v_mov_b32 v102, v115
    v_mov_b32 v103, v115
    v_mov_b32 v104, v115
    v_mov_b32 v105, v115
    v_mov_b32 v106, v115
    v_mov_b32 v107, v115
    v_mov_b32 v108, v115
    v_mov_b32 v109, v115
    v_mov_b32 v110, v115
    v_mov_b32 v111, v115
    s_mov_b32 s44, 0x0000ffff
    s_mov_b32 s45, 0x0000ffff
    s_mov_b32 s46, 0
    v_mov_b32 v64, 0
    v_mov_b32 v65, 0
    v_mov_b32 v66, 0
    v_mov_b32 v67, 0
    v_mov_b32 v68, 0
    v_mov_b32 v69, 0
    v_mov_b32 v70, 0
    v_mov_b32 v71, 0
    v_mov_b32 v72, 0
    v_mov_b32 v73, 0
    v_mov_b32 v74, 0
    v_mov_b32 v75, 0
    v_mov_b32 v76, 0
    v_mov_b32 v77, 0
    v_mov_b32 v78, 0
    v_mov_b32 v79, 0
    v_mov_b32 v80, 0
    v_mov_b32 v81, 0
    v_mov_b32 v82, 0
    v_mov_b32 v83, 0
    v_mov_b32 v84, 0
    v_mov_b32 v85, 0
    v_mov_b32 v86, 0
    v_mov_b32 v87, 0
    s_waitcnt vmcnt(0)
    s_barrier
    s_lshl_b32 s49, s48, 11
    s_add_u32 s49, s49, s66
    s_add_u32 s49, s49, 8192
    s_add_u32 s50, s49, 2097152
    s_add_u32 s40, s30, s50
    s_addc_u32 s41, s31, 0
    s_mov_b32 m0, s49
    s_nop 0
    global_load_lds_dwordx4 v3, s[40:41] offset:0
    global_load_lds_dwordx4 v3, s[40:41] offset:1024
    s_lshl_b32 s49, s48, 12
    s_add_u32 s49, s49, s66
    s_add_u32 s49, s49, 16384
    s_add_u32 s50, s49, 2097152
    s_add_u32 s68, s30, s50
    s_addc_u32 s69, s31, 0
    s_mov_b32 m0, s49
    s_lshr_b32 s50, s3, 1
    s_lshl_b32 s55, s57, 4
    s_lshl_b32 s54, s50, 12
    s_add_u32 s54, s54, 131072
    ds_read_b128 v[88:91], v112
    ds_read_b128 v[92:95], v112 offset:1024
    s_waitcnt lgkmcnt(1)
    v_mfma_f32_32x32x16_bf16 v[24:39], v[88:91], v[4:7], 0
    s_nop 15
    s_nop 3
    v_max3_f32 v114, v24, v25, v26
    v_max3_f32 v115, v27, v28, v29
    v_max3_f32 v116, v30, v31, v32
    v_max3_f32 v117, v33, v34, v35
    v_max3_f32 v114, v114, v36, v37
    v_max3_f32 v115, v115, v38, v39
    v_max3_f32 v114, v114, v116, v117
    v_max_f32 v114, v114, v115
    v_mov_b32 v115, v114
    s_nop 1
    v_permlane32_swap_b32 v114, v115
    s_nop 1
    v_max_f32 v114, v114, v115
    v_sub_f32 v8, 0, v114
    v_sub_f32 v9, 0, v114
    v_sub_f32 v10, 0, v114
    v_sub_f32 v11, 0, v114
    v_sub_f32 v12, 0, v114
    v_sub_f32 v13, 0, v114
    v_sub_f32 v14, 0, v114
    v_sub_f32 v15, 0, v114
    v_sub_f32 v16, 0, v114
    v_sub_f32 v17, 0, v114
    v_sub_f32 v18, 0, v114
    v_sub_f32 v19, 0, v114
    v_sub_f32 v20, 0, v114
    v_sub_f32 v21, 0, v114
    v_sub_f32 v22, 0, v114
    v_sub_f32 v23, 0, v114
    s_nop 1
    v_mfma_f32_32x32x16_bf16 v[24:39], v[88:91], v[4:7], v[8:23]
    s_waitcnt lgkmcnt(0)
    v_mfma_f32_32x32x16_bf16 v[40:55], v[92:95], v[4:7], v[8:23]
    ds_read_b128 v[88:91], v112 offset:2048
    s_nop 15
    s_nop 7
    v_exp_f32 v24, v24
    v_exp_f32 v25, v25
    v_exp_f32 v26, v26
    v_exp_f32 v27, v27
    v_exp_f32 v28, v28
    v_mfma_f32_32x32x16_bf16 v[72:87], v[104:107], v[64:67], v[72:87]
    v_exp_f32 v29, v29
    v_exp_f32 v30, v30
    v_exp_f32 v31, v31
    v_exp_f32 v32, v32
    v_exp_f32 v33, v33
    v_mfma_f32_32x32x16_bf16 v[72:87], v[108:111], v[68:71], v[72:87]
    s_mov_b64 exec, s[44:45]
    ds_read_b128 v[96:99], v113 offset:0
    ds_read_b128 v[100:103], v113 offset:512
    s_mov_b64 exec, -1
    global_load_lds_dwordx4 v3, s[68:69] offset:0
    v_exp_f32 v34, v34
    v_exp_f32 v35, v35
    v_exp_f32 v36, v36
    v_exp_f32 v37, v37
    v_exp_f32 v38, v38
    v_exp_f32 v39, v39
    v_cvt_pk_bf16_f32 v56, v24, v25
    v_cvt_pk_bf16_f32 v57, v26, v27
    v_cvt_pk_bf16_f32 v58, v28, v29
    v_cvt_pk_bf16_f32 v59, v30, v31
    v_cvt_pk_bf16_f32 v60, v32, v33
    v_cvt_pk_bf16_f32 v61, v34, v35
    v_cvt_pk_bf16_f32 v62, v36, v37
    v_cvt_pk_bf16_f32 v63, v38, v39
    s_waitcnt lgkmcnt(0)
    v_mfma_f32_32x32x16_bf16 v[24:39], v[88:91], v[4:7], v[8:23]
    ds_read_b128 v[92:95], v112 offset:3072
    v_exp_f32 v40, v40
    v_exp_f32 v41, v41
    v_exp_f32 v42, v42
    v_exp_f32 v43, v43
    v_exp_f32 v44, v44
    v_mfma_f32_32x32x16_bf16 v[72:87], v[96:99], v[56:59], v[72:87]
    v_exp_f32 v45, v45
    v_exp_f32 v46, v46
    v_exp_f32 v47, v47
    v_exp_f32 v48, v48
    v_exp_f32 v49, v49
    v_mfma_f32_32x32x16_bf16 v[72:87], v[100:103], v[60:63], v[72:87]
    s_mov_b64 exec, s[44:45]
    ds_read_b128 v[104:107], v113 offset:1024
    ds_read_b128 v[108:111], v113 offset:1536
    s_mov_b64 exec, -1
    global_load_lds_dwordx4 v3, s[68:69] offset:1024
    v_exp_f32 v50, v50
    v_exp_f32 v51, v51
    v_exp_f32 v52, v52
    v_exp_f32 v53, v53
    v_exp_f32 v54, v54
    v_exp_f32 v55, v55
    v_cvt_pk_bf16_f32 v64, v40, v41
    v_cvt_pk_bf16_f32 v65, v42, v43
    v_cvt_pk_bf16_f32 v66, v44, v45
    v_cvt_pk_bf16_f32 v67, v46, v47
    v_cvt_pk_bf16_f32 v68, v48, v49
    v_cvt_pk_bf16_f32 v69, v50, v51
    v_cvt_pk_bf16_f32 v70, v52, v53
    v_cvt_pk_bf16_f32 v71, v54, v55
    s_waitcnt lgkmcnt(0)
    v_mfma_f32_32x32x16_bf16 v[40:55], v[92:95], v[4:7], v[8:23]
    ds_read_b128 v[88:91], v112 offset:4096
    v_exp_f32 v24, v24
    v_exp_f32 v25, v25
    v_exp_f32 v26, v26
    v_exp_f32 v27, v27
    v_exp_f32 v28, v28
    v_mfma_f32_32x32x16_bf16 v[72:87], v[104:107], v[64:67], v[72:87]
    v_exp_f32 v29, v29
    v_exp_f32 v30, v30
    v_exp_f32 v31, v31
    v_exp_f32 v32, v32
    v_exp_f32 v33, v33
    v_mfma_f32_32x32x16_bf16 v[72:87], v[108:111], v[68:71], v[72:87]
    s_mov_b64 exec, s[44:45]
    ds_read_b128 v[96:99], v113 offset:2048
    ds_read_b128 v[100:103], v113 offset:2560
    s_mov_b64 exec, -1
    global_load_lds_dwordx4 v3, s[68:69] offset:2048
    v_exp_f32 v34, v34
    v_exp_f32 v35, v35
    v_exp_f32 v36, v36
    v_exp_f32 v37, v37
    v_exp_f32 v38, v38
    v_exp_f32 v39, v39
    v_cvt_pk_bf16_f32 v56, v24, v25
    v_cvt_pk_bf16_f32 v57, v26, v27
    v_cvt_pk_bf16_f32 v58, v28, v29
    v_cvt_pk_bf16_f32 v59, v30, v31
    v_cvt_pk_bf16_f32 v60, v32, v33
    v_cvt_pk_bf16_f32 v61, v34, v35
    v_cvt_pk_bf16_f32 v62, v36, v37
    v_cvt_pk_bf16_f32 v63, v38, v39
    s_waitcnt lgkmcnt(0)
    v_mfma_f32_32x32x16_bf16 v[24:39], v[88:91], v[4:7], v[8:23]
    ds_read_b128 v[92:95], v112 offset:5120
    v_exp_f32 v40, v40
    v_exp_f32 v41, v41
    v_exp_f32 v42, v42
    v_exp_f32 v43, v43
    v_exp_f32 v44, v44
    v_mfma_f32_32x32x16_bf16 v[72:87], v[96:99], v[56:59], v[72:87]
    v_exp_f32 v45, v45
    v_exp_f32 v46, v46
    v_exp_f32 v47, v47
    v_exp_f32 v48, v48
    v_exp_f32 v49, v49
    v_mfma_f32_32x32x16_bf16 v[72:87], v[100:103], v[60:63], v[72:87]
    s_mov_b64 exec, s[44:45]
    ds_read_b128 v[104:107], v113 offset:3072
    ds_read_b128 v[108:111], v113 offset:3584
    s_mov_b64 exec, -1
    global_load_lds_dwordx4 v3, s[68:69] offset:3072
    v_exp_f32 v50, v50
    v_exp_f32 v51, v51
    v_exp_f32 v52, v52
    v_exp_f32 v53, v53
    v_exp_f32 v54, v54
    v_exp_f32 v55, v55
    v_cvt_pk_bf16_f32 v64, v40, v41
    v_cvt_pk_bf16_f32 v65, v42, v43
    v_cvt_pk_bf16_f32 v66, v44, v45
    v_cvt_pk_bf16_f32 v67, v46, v47
    v_cvt_pk_bf16_f32 v68, v48, v49
    v_cvt_pk_bf16_f32 v69, v50, v51
    v_cvt_pk_bf16_f32 v70, v52, v53
    v_cvt_pk_bf16_f32 v71, v54, v55
    s_waitcnt lgkmcnt(0)
    v_mfma_f32_32x32x16_bf16 v[40:55], v[92:95], v[4:7], v[8:23]
    ds_read_b128 v[88:91], v112 offset:6144
    v_exp_f32 v24, v24
    v_exp_f32 v25, v25
    v_exp_f32 v26, v26
    v_exp_f32 v27, v27
    v_exp_f32 v28, v28
    v_mfma_f32_32x32x16_bf16 v[72:87], v[104:107], v[64:67], v[72:87]
    v_exp_f32 v29, v29
    v_exp_f32 v30, v30
    v_exp_f32 v31, v31
    v_exp_f32 v32, v32
    v_exp_f32 v33, v33
    v_mfma_f32_32x32x16_bf16 v[72:87], v[108:111], v[68:71], v[72:87]
    s_mov_b64 exec, s[44:45]
    ds_read_b128 v[96:99], v113 offset:4096
    ds_read_b128 v[100:103], v113 offset:4608
    s_mov_b64 exec, -1
    v_exp_f32 v34, v34
    v_exp_f32 v35, v35
    v_exp_f32 v36, v36
    v_exp_f32 v37, v37
    v_exp_f32 v38, v38
    v_exp_f32 v39, v39
    v_cvt_pk_bf16_f32 v56, v24, v25
    v_cvt_pk_bf16_f32 v57, v26, v27
    v_cvt_pk_bf16_f32 v58, v28, v29
    v_cvt_pk_bf16_f32 v59, v30, v31
    v_cvt_pk_bf16_f32 v60, v32, v33
    v_cvt_pk_bf16_f32 v61, v34, v35
    v_cvt_pk_bf16_f32 v62, v36, v37
    v_cvt_pk_bf16_f32 v63, v38, v39
    s_waitcnt lgkmcnt(0)
    v_mfma_f32_32x32x16_bf16 v[24:39], v[88:91], v[4:7], v[8:23]
    ds_read_b128 v[92:95], v112 offset:7168
    v_exp_f32 v40, v40
    v_exp_f32 v41, v41
    v_exp_f32 v42, v42
    v_exp_f32 v43, v43
    v_exp_f32 v44, v44
    v_mfma_f32_32x32x16_bf16 v[72:87], v[96:99], v[56:59], v[72:87]
    v_exp_f32 v45, v45
    v_exp_f32 v46, v46
    v_exp_f32 v47, v47
    v_exp_f32 v48, v48
    v_exp_f32 v49, v49
    v_mfma_f32_32x32x16_bf16 v[72:87], v[100:103], v[60:63], v[72:87]
    s_mov_b64 exec, s[44:45]
    ds_read_b128 v[104:107], v113 offset:5120
    ds_read_b128 v[108:111], v113 offset:5632
    s_mov_b64 exec, -1
    v_exp_f32 v50, v50
    v_exp_f32 v51, v51
    v_exp_f32 v52, v52
    v_exp_f32 v53, v53
    v_exp_f32 v54, v54
    v_exp_f32 v55, v55
    v_cvt_pk_bf16_f32 v64, v40, v41
    v_cvt_pk_bf16_f32 v65, v42, v43
    v_cvt_pk_bf16_f32 v66, v44, v45
    v_cvt_pk_bf16_f32 v67, v46, v47
    v_cvt_pk_bf16_f32 v68, v48, v49
    v_cvt_pk_bf16_f32 v69, v50, v51
    v_cvt_pk_bf16_f32 v70, v52, v53
    v_cvt_pk_bf16_f32 v71, v54, v55
    s_waitcnt vmcnt(4)
    s_barrier
    s_waitcnt lgkmcnt(0)
    v_mfma_f32_32x32x16_bf16 v[40:55], v[92:95], v[4:7], v[8:23]
    ds_read_b128 v[88:91], v112 offset:8192
    v_exp_f32 v24, v24
    v_exp_f32 v25, v25
    v_exp_f32 v26, v26
    v_exp_f32 v27, v27
    v_exp_f32 v28, v28
    v_mfma_f32_32x32x16_bf16 v[72:87], v[104:107], v[64:67], v[72:87]
    v_exp_f32 v29, v29
    v_exp_f32 v30, v30
    v_exp_f32 v31, v31
    v_exp_f32 v32, v32
    v_exp_f32 v33, v33
    v_mfma_f32_32x32x16_bf16 v[72:87], v[108:111], v[68:71], v[72:87]
    s_mov_b64 exec, s[44:45]
    ds_read_b128 v[96:99], v113 offset:6144
    ds_read_b128 v[100:103], v113 offset:6656
    s_mov_b64 exec, -1
    v_exp_f32 v34, v34
    v_exp_f32 v35, v35
    v_exp_f32 v36, v36
    v_exp_f32 v37, v37
    v_exp_f32 v38, v38
    v_exp_f32 v39, v39
    v_cvt_pk_bf16_f32 v56, v24, v25
    v_cvt_pk_bf16_f32 v57, v26, v27
    v_cvt_pk_bf16_f32 v58, v28, v29
    v_cvt_pk_bf16_f32 v59, v30, v31
    v_cvt_pk_bf16_f32 v60, v32, v33
    v_cvt_pk_bf16_f32 v61, v34, v35
    v_cvt_pk_bf16_f32 v62, v36, v37
    v_cvt_pk_bf16_f32 v63, v38, v39
    s_waitcnt lgkmcnt(0)
    v_mfma_f32_32x32x16_bf16 v[24:39], v[88:91], v[4:7], v[8:23]
    ds_read_b128 v[92:95], v112 offset:9216
    v_exp_f32 v40, v40
    v_exp_f32 v41, v41
    v_exp_f32 v42, v42
    v_exp_f32 v43, v43
    v_exp_f32 v44, v44
    v_mfma_f32_32x32x16_bf16 v[72:87], v[96:99], v[56:59], v[72:87]
    v_exp_f32 v45, v45
    v_exp_f32 v46, v46
    v_exp_f32 v47, v47
    v_exp_f32 v48, v48
    v_exp_f32 v49, v49
    v_mfma_f32_32x32x16_bf16 v[72:87], v[100:103], v[60:63], v[72:87]
    s_mov_b64 exec, s[44:45]
    ds_read_b128 v[104:107], v113 offset:7168
    ds_read_b128 v[108:111], v113 offset:7680
    s_mov_b64 exec, -1
    v_exp_f32 v50, v50
    v_exp_f32 v51, v51
    v_exp_f32 v52, v52
    v_exp_f32 v53, v53
    v_exp_f32 v54, v54
    v_exp_f32 v55, v55
    v_cvt_pk_bf16_f32 v64, v40, v41
    v_cvt_pk_bf16_f32 v65, v42, v43
    v_cvt_pk_bf16_f32 v66, v44, v45
    v_cvt_pk_bf16_f32 v67, v46, v47
    v_cvt_pk_bf16_f32 v68, v48, v49
    v_cvt_pk_bf16_f32 v69, v50, v51
    v_cvt_pk_bf16_f32 v70, v52, v53
    v_cvt_pk_bf16_f32 v71, v54, v55
    s_waitcnt lgkmcnt(0)
    v_mfma_f32_32x32x16_bf16 v[40:55], v[92:95], v[4:7], v[8:23]
    ds_read_b128 v[88:91], v112 offset:10240
    v_exp_f32 v24, v24
    v_exp_f32 v25, v25
    v_exp_f32 v26, v26
    v_exp_f32 v27, v27
    v_exp_f32 v28, v28
    v_mfma_f32_32x32x16_bf16 v[72:87], v[104:107], v[64:67], v[72:87]
    v_exp_f32 v29, v29
    v_exp_f32 v30, v30
    v_exp_f32 v31, v31
    v_exp_f32 v32, v32
    v_exp_f32 v33, v33
    v_mfma_f32_32x32x16_bf16 v[72:87], v[108:111], v[68:71], v[72:87]
    s_mov_b64 exec, s[44:45]
    ds_read_b128 v[96:99], v113 offset:8192
    ds_read_b128 v[100:103], v113 offset:8704
    s_mov_b64 exec, -1
    v_exp_f32 v34, v34
    v_exp_f32 v35, v35
    v_exp_f32 v36, v36
    v_exp_f32 v37, v37
    v_exp_f32 v38, v38
    v_exp_f32 v39, v39
    v_cvt_pk_bf16_f32 v56, v24, v25
    v_cvt_pk_bf16_f32 v57, v26, v27
    v_cvt_pk_bf16_f32 v58, v28, v29
    v_cvt_pk_bf16_f32 v59, v30, v31
    v_cvt_pk_bf16_f32 v60, v32, v33
    v_cvt_pk_bf16_f32 v61, v34, v35
    v_cvt_pk_bf16_f32 v62, v36, v37
    v_cvt_pk_bf16_f32 v63, v38, v39
    s_waitcnt lgkmcnt(0)
    v_mfma_f32_32x32x16_bf16 v[24:39], v[88:91], v[4:7], v[8:23]
    ds_read_b128 v[92:95], v112 offset:11264
    v_exp_f32 v40, v40
    v_exp_f32 v41, v41
    v_exp_f32 v42, v42
    v_exp_f32 v43, v43
    v_exp_f32 v44, v44
    v_mfma_f32_32x32x16_bf16 v[72:87], v[96:99], v[56:59], v[72:87]
    v_exp_f32 v45, v45
    v_exp_f32 v46, v46
    v_exp_f32 v47, v47
    v_exp_f32 v48, v48
    v_exp_f32 v49, v49
    v_mfma_f32_32x32x16_bf16 v[72:87], v[100:103], v[60:63], v[72:87]
    s_mov_b64 exec, s[44:45]
    ds_read_b128 v[104:107], v113 offset:9216
    ds_read_b128 v[108:111], v113 offset:9728
    s_mov_b64 exec, -1
    v_exp_f32 v50, v50
    v_exp_f32 v51, v51
    v_exp_f32 v52, v52
    v_exp_f32 v53, v53
    v_exp_f32 v54, v54
    v_exp_f32 v55, v55
    v_cvt_pk_bf16_f32 v64, v40, v41
    v_cvt_pk_bf16_f32 v65, v42, v43
    v_cvt_pk_bf16_f32 v66, v44, v45
    v_cvt_pk_bf16_f32 v67, v46, v47
    v_cvt_pk_bf16_f32 v68, v48, v49
    v_cvt_pk_bf16_f32 v69, v50, v51
    v_cvt_pk_bf16_f32 v70, v52, v53
    v_cvt_pk_bf16_f32 v71, v54, v55
    s_waitcnt lgkmcnt(0)
    v_mfma_f32_32x32x16_bf16 v[40:55], v[92:95], v[4:7], v[8:23]
    ds_read_b128 v[88:91], v112 offset:12288
    v_exp_f32 v24, v24
    v_exp_f32 v25, v25
    v_exp_f32 v26, v26
    v_exp_f32 v27, v27
    v_exp_f32 v28, v28
    v_mfma_f32_32x32x16_bf16 v[72:87], v[104:107], v[64:67], v[72:87]
    v_exp_f32 v29, v29
    v_exp_f32 v30, v30
    v_exp_f32 v31, v31
    v_exp_f32 v32, v32
    v_exp_f32 v33, v33
    v_mfma_f32_32x32x16_bf16 v[72:87], v[108:111], v[68:71], v[72:87]
    s_mov_b64 exec, s[44:45]
    ds_read_b128 v[96:99], v113 offset:10240
    ds_read_b128 v[100:103], v113 offset:10752
    s_mov_b64 exec, -1
    v_exp_f32 v34, v34
    v_exp_f32 v35, v35
    v_exp_f32 v36, v36
    v_exp_f32 v37, v37
    v_exp_f32 v38, v38
    v_exp_f32 v39, v39
    v_cvt_pk_bf16_f32 v56, v24, v25
    v_cvt_pk_bf16_f32 v57, v26, v27
    v_cvt_pk_bf16_f32 v58, v28, v29
    v_cvt_pk_bf16_f32 v59, v30, v31
    v_cvt_pk_bf16_f32 v60, v32, v33
    v_cvt_pk_bf16_f32 v61, v34, v35
    v_cvt_pk_bf16_f32 v62, v36, v37
    v_cvt_pk_bf16_f32 v63, v38, v39
    s_waitcnt lgkmcnt(0)
    v_mfma_f32_32x32x16_bf16 v[24:39], v[88:91], v[4:7], v[8:23]
    ds_read_b128 v[92:95], v112 offset:13312
    v_exp_f32 v40, v40
    v_exp_f32 v41, v41
    v_exp_f32 v42, v42
    v_exp_f32 v43, v43
    v_exp_f32 v44, v44
    v_mfma_f32_32x32x16_bf16 v[72:87], v[96:99], v[56:59], v[72:87]
    v_exp_f32 v45, v45
    v_exp_f32 v46, v46
    v_exp_f32 v47, v47
    v_exp_f32 v48, v48
    v_exp_f32 v49, v49
    v_mfma_f32_32x32x16_bf16 v[72:87], v[100:103], v[60:63], v[72:87]
    s_mov_b64 exec, s[44:45]
    ds_read_b128 v[104:107], v113 offset:11264
    ds_read_b128 v[108:111], v113 offset:11776
    s_mov_b64 exec, -1
    v_exp_f32 v50, v50
    v_exp_f32 v51, v51
    v_exp_f32 v52, v52
    v_exp_f32 v53, v53
    v_exp_f32 v54, v54
    v_exp_f32 v55, v55
    v_cvt_pk_bf16_f32 v64, v40, v41
    v_cvt_pk_bf16_f32 v65, v42, v43
    v_cvt_pk_bf16_f32 v66, v44, v45
    v_cvt_pk_bf16_f32 v67, v46, v47
    v_cvt_pk_bf16_f32 v68, v48, v49
    v_cvt_pk_bf16_f32 v69, v50, v51
    v_cvt_pk_bf16_f32 v70, v52, v53
    v_cvt_pk_bf16_f32 v71, v54, v55
    s_waitcnt lgkmcnt(0)
    v_mfma_f32_32x32x16_bf16 v[40:55], v[92:95], v[4:7], v[8:23]
    ds_read_b128 v[88:91], v112 offset:14336
    v_exp_f32 v24, v24
    v_exp_f32 v25, v25
    v_exp_f32 v26, v26
    v_exp_f32 v27, v27
    v_exp_f32 v28, v28
    v_mfma_f32_32x32x16_bf16 v[72:87], v[104:107], v[64:67], v[72:87]
    v_exp_f32 v29, v29
    v_exp_f32 v30, v30
    v_exp_f32 v31, v31
    v_exp_f32 v32, v32
    v_exp_f32 v33, v33
    v_mfma_f32_32x32x16_bf16 v[72:87], v[108:111], v[68:71], v[72:87]
    s_mov_b64 exec, s[44:45]
    ds_read_b128 v[96:99], v113 offset:12288
    ds_read_b128 v[100:103], v113 offset:12800
    s_mov_b64 exec, -1
    v_exp_f32 v34, v34
    v_exp_f32 v35, v35
    v_exp_f32 v36, v36
    v_exp_f32 v37, v37
    v_exp_f32 v38, v38
    v_exp_f32 v39, v39
    v_cvt_pk_bf16_f32 v56, v24, v25
    v_cvt_pk_bf16_f32 v57, v26, v27
    v_cvt_pk_bf16_f32 v58, v28, v29
    v_cvt_pk_bf16_f32 v59, v30, v31
    v_cvt_pk_bf16_f32 v60, v32, v33
    v_cvt_pk_bf16_f32 v61, v34, v35
    v_cvt_pk_bf16_f32 v62, v36, v37
    v_cvt_pk_bf16_f32 v63, v38, v39
    s_waitcnt lgkmcnt(0)
    v_mfma_f32_32x32x16_bf16 v[24:39], v[88:91], v[4:7], v[8:23]
    ds_read_b128 v[92:95], v112 offset:15360
    v_exp_f32 v40, v40
    v_exp_f32 v41, v41
    v_exp_f32 v42, v42
    v_exp_f32 v43, v43
    v_exp_f32 v44, v44
    v_mfma_f32_32x32x16_bf16 v[72:87], v[96:99], v[56:59], v[72:87]
    v_exp_f32 v45, v45
    v_exp_f32 v46, v46
    v_exp_f32 v47, v47
    v_exp_f32 v48, v48
    v_exp_f32 v49, v49
    v_mfma_f32_32x32x16_bf16 v[72:87], v[100:103], v[60:63], v[72:87]
    s_mov_b64 exec, s[44:45]
    ds_read_b128 v[104:107], v113 offset:13312
    ds_read_b128 v[108:111], v113 offset:13824
    s_mov_b64 exec, -1
    v_exp_f32 v50, v50
    v_exp_f32 v51, v51
    v_exp_f32 v52, v52
    v_exp_f32 v53, v53
    v_exp_f32 v54, v54
    v_exp_f32 v55, v55
    v_cvt_pk_bf16_f32 v64, v40, v41
    v_cvt_pk_bf16_f32 v65, v42, v43
    v_cvt_pk_bf16_f32 v66, v44, v45
    v_cvt_pk_bf16_f32 v67, v46, v47
    v_cvt_pk_bf16_f32 v68, v48, v49
    v_cvt_pk_bf16_f32 v69, v50, v51
    v_cvt_pk_bf16_f32 v70, v52, v53
    v_cvt_pk_bf16_f32 v71, v54, v55
    s_waitcnt vmcnt(0)
    s_barrier
    s_waitcnt lgkmcnt(0)
    v_mfma_f32_32x32x16_bf16 v[40:55], v[92:95], v[4:7], v[8:23]
    ds_read_b128 v[88:91], v112 offset:16384
    v_exp_f32 v24, v24
    v_exp_f32 v25, v25
    v_exp_f32 v26, v26
    v_exp_f32 v27, v27
    v_exp_f32 v28, v28
    v_mfma_f32_32x32x16_bf16 v[72:87], v[104:107], v[64:67], v[72:87]
    v_exp_f32 v29, v29
    v_exp_f32 v30, v30
    v_exp_f32 v31, v31
    v_exp_f32 v32, v32
    v_exp_f32 v33, v33
    v_mfma_f32_32x32x16_bf16 v[72:87], v[108:111], v[68:71], v[72:87]
    s_mov_b64 exec, s[44:45]
    ds_read_b128 v[96:99], v113 offset:14336
    ds_read_b128 v[100:103], v113 offset:14848
    s_mov_b64 exec, -1
    s_cmp_eq_u32 s62, 0
    s_cbranch_scc1 L_k2pi_7
    s_add_u32 m0, s54, 0
    s_nop 0
    global_load_lds_dwordx4 v120, s[58:59]
    s_add_u32 s58, s58, s55
    s_addc_u32 s59, s59, 0
L_k2pi_7:
    v_exp_f32 v34, v34
    v_exp_f32 v35, v35
    v_exp_f32 v36, v36
    v_exp_f32 v37, v37
    v_exp_f32 v38, v38
    v_exp_f32 v39, v39
    v_cvt_pk_bf16_f32 v56, v24, v25
    v_cvt_pk_bf16_f32 v57, v26, v27
    v_cvt_pk_bf16_f32 v58, v28, v29
    v_cvt_pk_bf16_f32 v59, v30, v31
    v_cvt_pk_bf16_f32 v60, v32, v33
    v_cvt_pk_bf16_f32 v61, v34, v35
    v_cvt_pk_bf16_f32 v62, v36, v37
    v_cvt_pk_bf16_f32 v63, v38, v39
    s_waitcnt lgkmcnt(0)
    v_mfma_f32_32x32x16_bf16 v[24:39], v[88:91], v[4:7], v[8:23]
    ds_read_b128 v[92:95], v112 offset:17408
    v_exp_f32 v40, v40
    v_exp_f32 v41, v41
    v_exp_f32 v42, v42
    v_exp_f32 v43, v43
    v_exp_f32 v44, v44
    v_mfma_f32_32x32x16_bf16 v[72:87], v[96:99], v[56:59], v[72:87]
    v_exp_f32 v45, v45
    v_exp_f32 v46, v46
    v_exp_f32 v47, v47
    v_exp_f32 v48, v48
    v_exp_f32 v49, v49
    v_mfma_f32_32x32x16_bf16 v[72:87], v[100:103], v[60:63], v[72:87]
    s_mov_b64 exec, s[44:45]
    ds_read_b128 v[104:107], v113 offset:15360
    ds_read_b128 v[108:111], v113 offset:15872
    s_mov_b64 exec, -1
    s_cmp_eq_u32 s62, 0
    s_cbranch_scc1 L_k2pi_8
    s_add_u32 m0, s54, 1024
    s_nop 0
    global_load_lds_dwordx4 v120, s[58:59]
    s_add_u32 s58, s58, s55
    s_addc_u32 s59, s59, 0
L_k2pi_8:
    v_exp_f32 v50, v50
    v_exp_f32 v51, v51
    v_exp_f32 v52, v52
    v_exp_f32 v53, v53
    v_exp_f32 v54, v54
    v_exp_f32 v55, v55
    v_cvt_pk_bf16_f32 v64, v40, v41
    v_cvt_pk_bf16_f32 v65, v42, v43
    v_cvt_pk_bf16_f32 v66, v44, v45
    v_cvt_pk_bf16_f32 v67, v46, v47
    v_cvt_pk_bf16_f32 v68, v48, v49
    v_cvt_pk_bf16_f32 v69, v50, v51
    v_cvt_pk_bf16_f32 v70, v52, v53
    v_cvt_pk_bf16_f32 v71, v54, v55
    s_waitcnt lgkmcnt(0)
    v_mfma_f32_32x32x16_bf16 v[40:55], v[92:95], v[4:7], v[8:23]
    ds_read_b128 v[88:91], v112 offset:18432
    v_exp_f32 v24, v24
    v_exp_f32 v25, v25
    v_exp_f32 v26, v26
    v_exp_f32 v27, v27
    v_exp_f32 v28, v28
    v_mfma_f32_32x32x16_bf16 v[72:87], v[104:107], v[64:67], v[72:87]
    v_exp_f32 v29, v29
    v_exp_f32 v30, v30
    v_exp_f32 v31, v31
    v_exp_f32 v32, v32
    v_exp_f32 v33, v33
    v_mfma_f32_32x32x16_bf16 v[72:87], v[108:111], v[68:71], v[72:87]
    s_mov_b64 exec, s[44:45]
    ds_read_b128 v[96:99], v113 offset:16384
    ds_read_b128 v[100:103], v113 offset:16896
    s_mov_b64 exec, -1
    s_cmp_lt_u32 s62, 4
    s_cbranch_scc1 L_k2pi_9
    s_add_u32 m0, s54, 2048
    s_nop 0
    global_load_lds_dwordx4 v120, s[58:59]
    s_add_u32 s58, s58, s55
    s_addc_u32 s59, s59, 0
L_k2pi_9:
    v_exp_f32 v34, v34
    v_exp_f32 v35, v35
    v_exp_f32 v36, v36
    v_exp_f32 v37, v37
    v_exp_f32 v38, v38
    v_exp_f32 v39, v39
    v_cvt_pk_bf16_f32 v56, v24, v25
    v_cvt_pk_bf16_f32 v57, v26, v27
    v_cvt_pk_bf16_f32 v58, v28, v29
    v_cvt_pk_bf16_f32 v59, v30, v31
    v_cvt_pk_bf16_f32 v60, v32, v33
    v_cvt_pk_bf16_f32 v61, v34, v35
    v_cvt_pk_bf16_f32 v62, v36, v37
    v_cvt_pk_bf16_f32 v63, v38, v39
    s_waitcnt lgkmcnt(0)
    v_mfma_f32_32x32x16_bf16 v[24:39], v[88:91], v[4:7], v[8:23]
    ds_read_b128 v[92:95], v112 offset:19456
    v_exp_f32 v40, v40
    v_exp_f32 v41, v41
    v_exp_f32 v42, v42
    v_exp_f32 v43, v43
    v_exp_f32 v44, v44
    v_mfma_f32_32x32x16_bf16 v[72:87], v[96:99], v[56:59], v[72:87]
    v_exp_f32 v45, v45
    v_exp_f32 v46, v46
    v_exp_f32 v47, v47
    v_exp_f32 v48, v48
    v_exp_f32 v49, v49
    v_mfma_f32_32x32x16_bf16 v[72:87], v[100:103], v[60:63], v[72:87]
    s_mov_b64 exec, s[44:45]
    ds_read_b128 v[104:107], v113 offset:17408
    ds_read_b128 v[108:111], v113 offset:17920
    s_mov_b64 exec, -1
    s_cmp_lt_u32 s62, 4
    s_cbranch_scc1 L_k2pi_10
    s_add_u32 m0, s54, 3072
    s_nop 0
    global_load_lds_dwordx4 v120, s[58:59]
L_k2pi_10:
    v_exp_f32 v50, v50
    v_exp_f32 v51, v51
    v_exp_f32 v52, v52
    v_exp_f32 v53, v53
    v_exp_f32 v54, v54
    v_exp_f32 v55, v55
    v_cvt_pk_bf16_f32 v64, v40, v41
    v_cvt_pk_bf16_f32 v65, v42, v43
    v_cvt_pk_bf16_f32 v66, v44, v45
    v_cvt_pk_bf16_f32 v67, v46, v47
    v_cvt_pk_bf16_f32 v68, v48, v49
    v_cvt_pk_bf16_f32 v69, v50, v51
    v_cvt_pk_bf16_f32 v70, v52, v53
    v_cvt_pk_bf16_f32 v71, v54, v55
    s_waitcnt lgkmcnt(0)
    v_mfma_f32_32x32x16_bf16 v[40:55], v[92:95], v[4:7], v[8:23]
    ds_read_b128 v[88:91], v112 offset:20480
    v_exp_f32 v24, v24
    v_exp_f32 v25, v25
    v_exp_f32 v26, v26
    v_exp_f32 v27, v27
    v_exp_f32 v28, v28
    v_mfma_f32_32x32x16_bf16 v[72:87], v[104:107], v[64:67], v[72:87]
    v_exp_f32 v29, v29
    v_exp_f32 v30, v30
    v_exp_f32 v31, v31
    v_exp_f32 v32, v32
    v_exp_f32 v33, v33
    v_mfma_f32_32x32x16_bf16 v[72:87], v[108:111], v[68:71], v[72:87]
    s_mov_b64 exec, s[44:45]
    ds_read_b128 v[96:99], v113 offset:18432
    ds_read_b128 v[100:103], v113 offset:18944
    s_mov_b64 exec, -1
    v_exp_f32 v34, v34
    v_exp_f32 v35, v35
    v_exp_f32 v36, v36
    v_exp_f32 v37, v37
    v_exp_f32 v38, v38
    v_exp_f32 v39, v39
    v_cvt_pk_bf16_f32 v56, v24, v25
    v_cvt_pk_bf16_f32 v57, v26, v27
    v_cvt_pk_bf16_f32 v58, v28, v29
    v_cvt_pk_bf16_f32 v59, v30, v31
    v_cvt_pk_bf16_f32 v60, v32, v33
    v_cvt_pk_bf16_f32 v61, v34, v35
    v_cvt_pk_bf16_f32 v62, v36, v37
    v_cvt_pk_bf16_f32 v63, v38, v39
    s_waitcnt lgkmcnt(0)
    v_mfma_f32_32x32x16_bf16 v[24:39], v[88:91], v[4:7], v[8:23]
    ds_read_b128 v[92:95], v112 offset:21504
    v_exp_f32 v40, v40
    v_exp_f32 v41, v41
    v_exp_f32 v42, v42
    v_exp_f32 v43, v43
    v_exp_f32 v44, v44
    v_mfma_f32_32x32x16_bf16 v[72:87], v[96:99], v[56:59], v[72:87]
    v_exp_f32 v45, v45
    v_exp_f32 v46, v46
    v_exp_f32 v47, v47
    v_exp_f32 v48, v48
    v_exp_f32 v49, v49
    v_mfma_f32_32x32x16_bf16 v[72:87], v[100:103], v[60:63], v[72:87]
    s_mov_b64 exec, s[44:45]
    ds_read_b128 v[104:107], v113 offset:19456
    ds_read_b128 v[108:111], v113 offset:19968
    s_mov_b64 exec, -1
    v_exp_f32 v50, v50
    v_exp_f32 v51, v51
    v_exp_f32 v52, v52
    v_exp_f32 v53, v53
    v_exp_f32 v54, v54
    v_exp_f32 v55, v55
    v_cvt_pk_bf16_f32 v64, v40, v41
    v_cvt_pk_bf16_f32 v65, v42, v43
    v_cvt_pk_bf16_f32 v66, v44, v45
    v_cvt_pk_bf16_f32 v67, v46, v47
    v_cvt_pk_bf16_f32 v68, v48, v49
    v_cvt_pk_bf16_f32 v69, v50, v51
    v_cvt_pk_bf16_f32 v70, v52, v53
    v_cvt_pk_bf16_f32 v71, v54, v55
    s_waitcnt lgkmcnt(0)
    v_mfma_f32_32x32x16_bf16 v[40:55], v[92:95], v[4:7], v[8:23]
    ds_read_b128 v[88:91], v112 offset:22528
    v_exp_f32 v24, v24
    v_exp_f32 v25, v25
    v_exp_f32 v26, v26
    v_exp_f32 v27, v27
    v_exp_f32 v28, v28
    v_mfma_f32_32x32x16_bf16 v[72:87], v[104:107], v[64:67], v[72:87]
    v_exp_f32 v29, v29
    v_exp_f32 v30, v30
    v_exp_f32 v31, v31
    v_exp_f32 v32, v32
    v_exp_f32 v33, v33
    v_mfma_f32_32x32x16_bf16 v[72:87], v[108:111], v[68:71], v[72:87]
    s_mov_b64 exec, s[44:45]
    ds_read_b128 v[96:99], v113 offset:20480
    ds_read_b128 v[100:103], v113 offset:20992
    s_mov_b64 exec, -1
    v_exp_f32 v34, v34
    v_exp_f32 v35, v35
    v_exp_f32 v36, v36
    v_exp_f32 v37, v37
    v_exp_f32 v38, v38
    v_exp_f32 v39, v39
    v_cvt_pk_bf16_f32 v56, v24, v25
    v_cvt_pk_bf16_f32 v57, v26, v27
    v_cvt_pk_bf16_f32 v58, v28, v29
    v_cvt_pk_bf16_f32 v59, v30, v31
    v_cvt_pk_bf16_f32 v60, v32, v33
    v_cvt_pk_bf16_f32 v61, v34, v35
    v_cvt_pk_bf16_f32 v62, v36, v37
    v_cvt_pk_bf16_f32 v63, v38, v39
    s_waitcnt lgkmcnt(0)
    v_mfma_f32_32x32x16_bf16 v[24:39], v[88:91], v[4:7], v[8:23]
    ds_read_b128 v[92:95], v112 offset:23552
    v_exp_f32 v40, v40
    v_exp_f32 v41, v41
    v_exp_f32 v42, v42
    v_exp_f32 v43, v43
    v_exp_f32 v44, v44
    v_mfma_f32_32x32x16_bf16 v[72:87], v[96:99], v[56:59], v[72:87]
    v_exp_f32 v45, v45
    v_exp_f32 v46, v46
    v_exp_f32 v47, v47
    v_exp_f32 v48, v48
    v_exp_f32 v49, v49
    v_mfma_f32_32x32x16_bf16 v[72:87], v[100:103], v[60:63], v[72:87]
    s_mov_b64 exec, s[44:45]
    ds_read_b128 v[104:107], v113 offset:21504
    ds_read_b128 v[108:111], v113 offset:22016
    s_mov_b64 exec, -1
    v_exp_f32 v50, v50
    v_exp_f32 v51, v51
    v_exp_f32 v52, v52
    v_exp_f32 v53, v53
    v_exp_f32 v54, v54
    v_exp_f32 v55, v55
    v_cvt_pk_bf16_f32 v64, v40, v41
    v_cvt_pk_bf16_f32 v65, v42, v43
    v_cvt_pk_bf16_f32 v66, v44, v45
    v_cvt_pk_bf16_f32 v67, v46, v47
    v_cvt_pk_bf16_f32 v68, v48, v49
    v_cvt_pk_bf16_f32 v69, v50, v51
    v_cvt_pk_bf16_f32 v70, v52, v53
    v_cvt_pk_bf16_f32 v71, v54, v55
    s_waitcnt lgkmcnt(0)
    v_mfma_f32_32x32x16_bf16 v[40:55], v[92:95], v[4:7], v[8:23]
    ds_read_b128 v[88:91], v112 offset:24576
    v_exp_f32 v24, v24
    v_exp_f32 v25, v25
    v_exp_f32 v26, v26
    v_exp_f32 v27, v27
    v_exp_f32 v28, v28
    v_mfma_f32_32x32x16_bf16 v[72:87], v[104:107], v[64:67], v[72:87]
    v_exp_f32 v29, v29
    v_exp_f32 v30, v30
    v_exp_f32 v31, v31
    v_exp_f32 v32, v32
    v_exp_f32 v33, v33
    v_mfma_f32_32x32x16_bf16 v[72:87], v[108:111], v[68:71], v[72:87]
    s_mov_b64 exec, s[44:45]
    ds_read_b128 v[96:99], v113 offset:22528
    ds_read_b128 v[100:103], v113 offset:23040
    s_mov_b64 exec, -1
    v_exp_f32 v34, v34
    v_exp_f32 v35, v35
    v_exp_f32 v36, v36
    v_exp_f32 v37, v37
    v_exp_f32 v38, v38
    v_exp_f32 v39, v39
    v_cvt_pk_bf16_f32 v56, v24, v25
    v_cvt_pk_bf16_f32 v57, v26, v27
    v_cvt_pk_bf16_f32 v58, v28, v29
    v_cvt_pk_bf16_f32 v59, v30, v31
    v_cvt_pk_bf16_f32 v60, v32, v33
    v_cvt_pk_bf16_f32 v61, v34, v35
    v_cvt_pk_bf16_f32 v62, v36, v37
    v_cvt_pk_bf16_f32 v63, v38, v39
    s_waitcnt lgkmcnt(0)
    v_mfma_f32_32x32x16_bf16 v[24:39], v[88:91], v[4:7], v[8:23]
    ds_read_b128 v[92:95], v112 offset:25600
    v_exp_f32 v40, v40
    v_exp_f32 v41, v41
    v_exp_f32 v42, v42
    v_exp_f32 v43, v43
    v_exp_f32 v44, v44
    v_mfma_f32_32x32x16_bf16 v[72:87], v[96:99], v[56:59], v[72:87]
    v_exp_f32 v45, v45
    v_exp_f32 v46, v46
    v_exp_f32 v47, v47
    v_exp_f32 v48, v48
    v_exp_f32 v49, v49
    v_mfma_f32_32x32x16_bf16 v[72:87], v[100:103], v[60:63], v[72:87]
    s_mov_b64 exec, s[44:45]
    ds_read_b128 v[104:107], v113 offset:23552
    ds_read_b128 v[108:111], v113 offset:24064
    s_mov_b64 exec, -1
    v_exp_f32 v50, v50
    v_exp_f32 v51, v51
    v_exp_f32 v52, v52
    v_exp_f32 v53, v53
    v_exp_f32 v54, v54
    v_exp_f32 v55, v55
    v_cvt_pk_bf16_f32 v64, v40, v41
    v_cvt_pk_bf16_f32 v65, v42, v43
    v_cvt_pk_bf16_f32 v66, v44, v45
    v_cvt_pk_bf16_f32 v67, v46, v47
    v_cvt_pk_bf16_f32 v68, v48, v49
    v_cvt_pk_bf16_f32 v69, v50, v51
    v_cvt_pk_bf16_f32 v70, v52, v53
    v_cvt_pk_bf16_f32 v71, v54, v55
    s_waitcnt lgkmcnt(0)
    v_mfma_f32_32x32x16_bf16 v[40:55], v[92:95], v[4:7], v[8:23]
    ds_read_b128 v[88:91], v112 offset:26624
    v_exp_f32 v24, v24
    v_exp_f32 v25, v25
    v_exp_f32 v26, v26
    v_exp_f32 v27, v27
    v_exp_f32 v28, v28
    v_mfma_f32_32x32x16_bf16 v[72:87], v[104:107], v[64:67], v[72:87]
    v_exp_f32 v29, v29
    v_exp_f32 v30, v30
    v_exp_f32 v31, v31
    v_exp_f32 v32, v32
    v_exp_f32 v33, v33
    v_mfma_f32_32x32x16_bf16 v[72:87], v[108:111], v[68:71], v[72:87]
    s_mov_b64 exec, s[44:45]
    ds_read_b128 v[96:99], v113 offset:24576
    ds_read_b128 v[100:103], v113 offset:25088
    s_mov_b64 exec, -1
    v_exp_f32 v34, v34
    v_exp_f32 v35, v35
    v_exp_f32 v36, v36
    v_exp_f32 v37, v37
    v_exp_f32 v38, v38
    v_exp_f32 v39, v39
    v_cvt_pk_bf16_f32 v56, v24, v25
    v_cvt_pk_bf16_f32 v57, v26, v27
    v_cvt_pk_bf16_f32 v58, v28, v29
    v_cvt_pk_bf16_f32 v59, v30, v31
    v_cvt_pk_bf16_f32 v60, v32, v33
    v_cvt_pk_bf16_f32 v61, v34, v35
    v_cvt_pk_bf16_f32 v62, v36, v37
    v_cvt_pk_bf16_f32 v63, v38, v39
    s_waitcnt lgkmcnt(0)
    v_mfma_f32_32x32x16_bf16 v[24:39], v[88:91], v[4:7], v[8:23]
    ds_read_b128 v[92:95], v112 offset:27648
    v_exp_f32 v40, v40
    v_exp_f32 v41, v41
    v_exp_f32 v42, v42
    v_exp_f32 v43, v43
    v_exp_f32 v44, v44
    v_mfma_f32_32x32x16_bf16 v[72:87], v[96:99], v[56:59], v[72:87]
    v_exp_f32 v45, v45
    v_exp_f32 v46, v46
    v_exp_f32 v47, v47
    v_exp_f32 v48, v48
    v_exp_f32 v49, v49
    v_mfma_f32_32x32x16_bf16 v[72:87], v[100:103], v[60:63], v[72:87]
    s_mov_b64 exec, s[44:45]
    ds_read_b128 v[104:107], v113 offset:25600
    ds_read_b128 v[108:111], v113 offset:26112
    s_mov_b64 exec, -1
    v_exp_f32 v50, v50
    v_exp_f32 v51, v51
    v_exp_f32 v52, v52
    v_exp_f32 v53, v53
    v_exp_f32 v54, v54
    v_exp_f32 v55, v55
    v_cvt_pk_bf16_f32 v64, v40, v41
    v_cvt_pk_bf16_f32 v65, v42, v43
    v_cvt_pk_bf16_f32 v66, v44, v45
    v_cvt_pk_bf16_f32 v67, v46, v47
    v_cvt_pk_bf16_f32 v68, v48, v49
    v_cvt_pk_bf16_f32 v69, v50, v51
    v_cvt_pk_bf16_f32 v70, v52, v53
    v_cvt_pk_bf16_f32 v71, v54, v55
    s_waitcnt lgkmcnt(0)
    v_mfma_f32_32x32x16_bf16 v[40:55], v[92:95], v[4:7], v[8:23]
    ds_read_b128 v[88:91], v112 offset:28672
    v_exp_f32 v24, v24
    v_exp_f32 v25, v25
    v_exp_f32 v26, v26
    v_exp_f32 v27, v27
    v_exp_f32 v28, v28
    v_mfma_f32_32x32x16_bf16 v[72:87], v[104:107], v[64:67], v[72:87]
    v_exp_f32 v29, v29
    v_exp_f32 v30, v30
    v_exp_f32 v31, v31
    v_exp_f32 v32, v32
    v_exp_f32 v33, v33
    v_mfma_f32_32x32x16_bf16 v[72:87], v[108:111], v[68:71], v[72:87]
    s_mov_b64 exec, s[44:45]
    ds_read_b128 v[96:99], v113 offset:26624
    ds_read_b128 v[100:103], v113 offset:27136
    s_mov_b64 exec, -1
    v_exp_f32 v34, v34
    v_exp_f32 v35, v35
    v_exp_f32 v36, v36
    v_exp_f32 v37, v37
    v_exp_f32 v38, v38
    v_exp_f32 v39, v39
    v_cvt_pk_bf16_f32 v56, v24, v25
    v_cvt_pk_bf16_f32 v57, v26, v27
    v_cvt_pk_bf16_f32 v58, v28, v29
    v_cvt_pk_bf16_f32 v59, v30, v31
    v_cvt_pk_bf16_f32 v60, v32, v33
    v_cvt_pk_bf16_f32 v61, v34, v35
    v_cvt_pk_bf16_f32 v62, v36, v37
    v_cvt_pk_bf16_f32 v63, v38, v39
    s_cmp_eq_u32 s62, 0
    s_cbranch_scc1 L_k2_ppdone
    s_waitcnt vmcnt(0)
    v_lshrrev_b32 v118, 5, v1
    v_and_b32 v115, 15, v1
    v_lshrrev_b32 v114, 2, v115
    v_lshl_add_u32 v114, v118, 3, v114
    v_lshlrev_b32 v114, 6, v114
    v_bfe_u32 v118, v1, 4, 1
    v_lshl_add_u32 v114, v118, 5, v114
    v_and_b32 v115, 3, v115
    v_lshl_add_u32 v114, v115, 3, v114
    v_add_u32 v114, s54, v114
    v_mov_b32 v119, 0
    v_mov_b32 v115, 0
    v_mov_b32 v118, 0x3f803f80
    ds_read_b64_tr_b16 v[120:121], v114 offset:0
    ds_read_b64_tr_b16 v[122:123], v114 offset:256
    ds_read_b64_tr_b16 v[124:125], v114 offset:1024
    ds_read_b64_tr_b16 v[126:127], v114 offset:1280
    s_waitcnt lgkmcnt(0)
    global_store_dwordx4 v3, v[120:123], s[60:61] offset:0 sc0 sc1
    global_store_dwordx4 v3, v[124:127], s[60:61] offset:1024 sc0 sc1
    v_dot2c_f32_bf16 v119, v120, v118
    v_dot2c_f32_bf16 v115, v124, v118
    v_dot2c_f32_bf16 v119, v121, v118
    v_dot2c_f32_bf16 v115, v125, v118
    v_dot2c_f32_bf16 v119, v122, v118
    v_dot2c_f32_bf16 v115, v126, v118
    v_dot2c_f32_bf16 v119, v123, v118
    v_dot2c_f32_bf16 v115, v127, v118
    s_cmp_lt_u32 s62, 4
    s_cbranch_scc1 L_k2_ppdone
    ds_read_b64_tr_b16 v[120:121], v114 offset:2048
    ds_read_b64_tr_b16 v[122:123], v114 offset:2304
    ds_read_b64_tr_b16 v[124:125], v114 offset:3072
    ds_read_b64_tr_b16 v[126:127], v114 offset:3328
    s_waitcnt lgkmcnt(0)
    global_store_dwordx4 v3, v[120:123], s[60:61] offset:2048 sc0 sc1
    global_store_dwordx4 v3, v[124:127], s[60:61] offset:3072 sc0 sc1
    v_dot2c_f32_bf16 v119, v120, v118
    v_dot2c_f32_bf16 v115, v124, v118
    v_dot2c_f32_bf16 v119, v121, v118
    v_dot2c_f32_bf16 v115, v125, v118
    v_dot2c_f32_bf16 v119, v122, v118
    v_dot2c_f32_bf16 v115, v126, v118
    v_dot2c_f32_bf16 v119, v123, v118
    v_dot2c_f32_bf16 v115, v127, v118
    s_cmp_eq_u32 s63, 0
    s_cbranch_scc1 L_k2_ppdone
    v_add_f32 v119, v119, v115
    v_mov_b32 v115, v119
    s_nop 1
    v_permlane32_swap_b32 v119, v115
    s_nop 1
    v_add_f32 v119, v119, v115
    v_lshlrev_b32 v114, 2, v1
    v_cmp_gt_u32 vcc, 32, v1
    s_and_saveexec_b64 s[54:55], vcc
    global_store_dword v114, v119, s[64:65]
    s_mov_b64 exec, -1
L_k2_ppdone:
    s_waitcnt lgkmcnt(0)
    v_mfma_f32_32x32x16_bf16 v[24:39], v[88:91], v[4:7], v[8:23]
    ds_read_b128 v[92:95], v112 offset:29696
    v_exp_f32 v40, v40
    v_exp_f32 v41, v41
    v_exp_f32 v42, v42
    v_exp_f32 v43, v43
    v_exp_f32 v44, v44
    v_mfma_f32_32x32x16_bf16 v[72:87], v[96:99], v[56:59], v[72:87]
    v_exp_f32 v45, v45
    v_exp_f32 v46, v46
    v_exp_f32 v47, v47
    v_exp_f32 v48, v48
    v_exp_f32 v49, v49
    v_mfma_f32_32x32x16_bf16 v[72:87], v[100:103], v[60:63], v[72:87]
    s_mov_b64 exec, s[44:45]
    ds_read_b128 v[104:107], v113 offset:27648
    ds_read_b128 v[108:111], v113 offset:28160
    s_mov_b64 exec, -1
    v_exp_f32 v50, v50
    v_exp_f32 v51, v51
    v_exp_f32 v52, v52
    v_exp_f32 v53, v53
    v_exp_f32 v54, v54
    v_exp_f32 v55, v55
    v_cvt_pk_bf16_f32 v64, v40, v41
    v_cvt_pk_bf16_f32 v65, v42, v43
    v_cvt_pk_bf16_f32 v66, v44, v45
    v_cvt_pk_bf16_f32 v67, v46, v47
    v_cvt_pk_bf16_f32 v68, v48, v49
    v_cvt_pk_bf16_f32 v69, v50, v51
    v_cvt_pk_bf16_f32 v70, v52, v53
    v_cvt_pk_bf16_f32 v71, v54, v55
    s_waitcnt lgkmcnt(0)
    v_mfma_f32_32x32x16_bf16 v[40:55], v[92:95], v[4:7], v[8:23]
    ds_read_b128 v[88:91], v112 offset:30720
    v_exp_f32 v24, v24
    v_exp_f32 v25, v25
    v_exp_f32 v26, v26
    v_exp_f32 v27, v27
    v_exp_f32 v28, v28
    v_mfma_f32_32x32x16_bf16 v[72:87], v[104:107], v[64:67], v[72:87]
    v_exp_f32 v29, v29
    v_exp_f32 v30, v30
    v_exp_f32 v31, v31
    v_exp_f32 v32, v32
    v_exp_f32 v33, v33
    v_mfma_f32_32x32x16_bf16 v[72:87], v[108:111], v[68:71], v[72:87]
    s_mov_b64 exec, s[44:45]
    ds_read_b128 v[96:99], v113 offset:28672
    ds_read_b128 v[100:103], v113 offset:29184
    s_mov_b64 exec, -1
    v_exp_f32 v34, v34
    v_exp_f32 v35, v35
    v_exp_f32 v36, v36
    v_exp_f32 v37, v37
    v_exp_f32 v38, v38
    v_exp_f32 v39, v39
    v_cvt_pk_bf16_f32 v56, v24, v25
    v_cvt_pk_bf16_f32 v57, v26, v27
    v_cvt_pk_bf16_f32 v58, v28, v29
    v_cvt_pk_bf16_f32 v59, v30, v31
    v_cvt_pk_bf16_f32 v60, v32, v33
    v_cvt_pk_bf16_f32 v61, v34, v35
    v_cvt_pk_bf16_f32 v62, v36, v37
    v_cvt_pk_bf16_f32 v63, v38, v39
    s_waitcnt lgkmcnt(0)
    v_mfma_f32_32x32x16_bf16 v[24:39], v[88:91], v[4:7], v[8:23]
    ds_read_b128 v[92:95], v112 offset:31744
    v_exp_f32 v40, v40
    v_exp_f32 v41, v41
    v_exp_f32 v42, v42
    v_exp_f32 v43, v43
    v_exp_f32 v44, v44
    v_mfma_f32_32x32x16_bf16 v[72:87], v[96:99], v[56:59], v[72:87]
    v_exp_f32 v45, v45
    v_exp_f32 v46, v46
    v_exp_f32 v47, v47
    v_exp_f32 v48, v48
    v_exp_f32 v49, v49
    v_mfma_f32_32x32x16_bf16 v[72:87], v[100:103], v[60:63], v[72:87]
    s_mov_b64 exec, s[44:45]
    ds_read_b128 v[104:107], v113 offset:29696
    ds_read_b128 v[108:111], v113 offset:30208
    s_mov_b64 exec, -1
    v_exp_f32 v50, v50
    v_exp_f32 v51, v51
    v_exp_f32 v52, v52
    v_exp_f32 v53, v53
    v_exp_f32 v54, v54
    v_exp_f32 v55, v55
    v_cvt_pk_bf16_f32 v64, v40, v41
    v_cvt_pk_bf16_f32 v65, v42, v43
    v_cvt_pk_bf16_f32 v66, v44, v45
    v_cvt_pk_bf16_f32 v67, v46, v47
    v_cvt_pk_bf16_f32 v68, v48, v49
    v_cvt_pk_bf16_f32 v69, v50, v51
    v_cvt_pk_bf16_f32 v70, v52, v53
    v_cvt_pk_bf16_f32 v71, v54, v55
    s_waitcnt lgkmcnt(0)
    v_mfma_f32_32x32x16_bf16 v[40:55], v[92:95], v[4:7], v[8:23]
    ds_read_b128 v[88:91], v112 offset:32768
    v_exp_f32 v24, v24
    v_exp_f32 v25, v25
    v_exp_f32 v26, v26
    v_exp_f32 v27, v27
    v_exp_f32 v28, v28
    v_mfma_f32_32x32x16_bf16 v[72:87], v[104:107], v[64:67], v[72:87]
    v_exp_f32 v29, v29
    v_exp_f32 v30, v30
    v_exp_f32 v31, v31
    v_exp_f32 v32, v32
    v_exp_f32 v33, v33
    v_mfma_f32_32x32x16_bf16 v[72:87], v[108:111], v[68:71], v[72:87]
    s_mov_b64 exec, s[44:45]
    ds_read_b128 v[96:99], v113 offset:30720
    ds_read_b128 v[100:103], v113 offset:31232
    s_mov_b64 exec, -1
    v_exp_f32 v34, v34
    v_exp_f32 v35, v35
    v_exp_f32 v36, v36
    v_exp_f32 v37, v37
    v_exp_f32 v38, v38
    v_exp_f32 v39, v39
    v_cvt_pk_bf16_f32 v56, v24, v25
    v_cvt_pk_bf16_f32 v57, v26, v27
    v_cvt_pk_bf16_f32 v58, v28, v29
    v_cvt_pk_bf16_f32 v59, v30, v31
    v_cvt_pk_bf16_f32 v60, v32, v33
    v_cvt_pk_bf16_f32 v61, v34, v35
    v_cvt_pk_bf16_f32 v62, v36, v37
    v_cvt_pk_bf16_f32 v63, v38, v39
    s_waitcnt lgkmcnt(0)
    v_mfma_f32_32x32x16_bf16 v[24:39], v[88:91], v[4:7], v[8:23]
    ds_read_b128 v[92:95], v112 offset:33792
    v_exp_f32 v40, v40
    v_exp_f32 v41, v41
    v_exp_f32 v42, v42
    v_exp_f32 v43, v43
    v_exp_f32 v44, v44
    v_mfma_f32_32x32x16_bf16 v[72:87], v[96:99], v[56:59], v[72:87]
    v_exp_f32 v45, v45
    v_exp_f32 v46, v46
    v_exp_f32 v47, v47
    v_exp_f32 v48, v48
    v_exp_f32 v49, v49
    v_mfma_f32_32x32x16_bf16 v[72:87], v[100:103], v[60:63], v[72:87]
    s_mov_b64 exec, s[44:45]
    ds_read_b128 v[104:107], v113 offset:31744
    ds_read_b128 v[108:111], v113 offset:32256
    s_mov_b64 exec, -1
    v_exp_f32 v50, v50
    v_exp_f32 v51, v51
    v_exp_f32 v52, v52
    v_exp_f32 v53, v53
    v_exp_f32 v54, v54
    v_exp_f32 v55, v55
    v_cvt_pk_bf16_f32 v64, v40, v41
    v_cvt_pk_bf16_f32 v65, v42, v43
    v_cvt_pk_bf16_f32 v66, v44, v45
    v_cvt_pk_bf16_f32 v67, v46, v47
    v_cvt_pk_bf16_f32 v68, v48, v49
    v_cvt_pk_bf16_f32 v69, v50, v51
    v_cvt_pk_bf16_f32 v70, v52, v53
    v_cvt_pk_bf16_f32 v71, v54, v55
    s_waitcnt lgkmcnt(0)
    s_nop 1
    v_mfma_f32_32x32x16_bf16 v[72:87], v[104:107], v[64:67], v[72:87]
    v_mfma_f32_32x32x16_bf16 v[72:87], v[108:111], v[68:71], v[72:87]
    s_nop 15
    s_nop 3
    v_mul_f32 v114, 0x4d800000, v80
    v_mul_f32 v114, 0, v114
    v_fma_f32 v114, v72, 0, v114
    v_fma_f32 v114, v73, 0, v114
    v_fma_f32 v114, v74, 0, v114
    v_fma_f32 v114, v75, 0, v114
    v_fma_f32 v114, v76, 0, v114
    v_fma_f32 v114, v77, 0, v114
    v_fma_f32 v114, v78, 0, v114
    v_fma_f32 v114, v79, 0, v114
    v_cmp_u_f32 vcc, v114, v114
    s_cbranch_vccz L_k2_merge
    v_mov_b32 v116, v112
    v_mov_b32 v114, 0xff800000
    s_mov_b32 s47, 32
L_k2_fb:
    ds_read_b128 v[88:91], v116 offset:0
    s_waitcnt lgkmcnt(0)
    v_mfma_f32_32x32x16_bf16 v[24:39], v[88:91], v[4:7], 0
    s_nop 15
    s_nop 3
    v_max3_f32 v114, v114, v24, v25
    v_max3_f32 v114, v114, v26, v27
    v_max3_f32 v114, v114, v28, v29
    v_max3_f32 v114, v114, v30, v31
    v_max3_f32 v114, v114, v32, v33
    v_max3_f32 v114, v114, v34, v35
    v_max3_f32 v114, v114, v36, v37
    v_max3_f32 v114, v114, v38, v39
    v_add_u32 v116, 1024, v116
    s_sub_u32 s47, s47, 1
    s_cmp_lg_u32 s47, 0
    s_cbranch_scc1 L_k2_fb
    v_mov_b32 v115, v114
    s_nop 1
    v_permlane32_swap_b32 v114, v115
    s_nop 1
    v_max_f32 v114, v114, v115
    v_sub_f32 v8, 0, v114
    v_sub_f32 v9, 0, v114
    v_sub_f32 v10, 0, v114
    v_sub_f32 v11, 0, v114
    v_sub_f32 v12, 0, v114
    v_sub_f32 v13, 0, v114
    v_sub_f32 v14, 0, v114
    v_sub_f32 v15, 0, v114
    v_sub_f32 v16, 0, v114
    v_sub_f32 v17, 0, v114
    v_sub_f32 v18, 0, v114
    v_sub_f32 v19, 0, v114
    v_sub_f32 v20, 0, v114
    v_sub_f32 v21, 0, v114
    v_sub_f32 v22, 0, v114
    v_sub_f32 v23, 0, v114
    v_mov_b32 v72, 0
    v_mov_b32 v73, 0
    v_mov_b32 v74, 0
    v_mov_b32 v75, 0
    v_mov_b32 v76, 0
    v_mov_b32 v77, 0
    v_mov_b32 v78, 0
    v_mov_b32 v79, 0
    v_mov_b32 v80, 0
    v_mov_b32 v81, 0
    v_mov_b32 v82, 0
    v_mov_b32 v83, 0
    v_mov_b32 v84, 0
    v_mov_b32 v85, 0
    v_mov_b32 v86, 0
    v_mov_b32 v87, 0
    v_mov_b32 v64, 0
    v_mov_b32 v65, 0
    v_mov_b32 v66, 0
    v_mov_b32 v67, 0
    v_mov_b32 v68, 0
    v_mov_b32 v69, 0
    v_mov_b32 v70, 0
    v_mov_b32 v71, 0
    v_mov_b32 v116, v112
    v_mov_b32 v117, v113
    ds_read_b128 v[88:91], v116 offset:0
    ds_read_b128 v[92:95], v116 offset:1024
    s_waitcnt lgkmcnt(1)
    v_mfma_f32_32x32x16_bf16 v[24:39], v[88:91], v[4:7], v[8:23]
    s_mov_b32 s47, 16
L_k2_loop:
    s_waitcnt lgkmcnt(0)
    v_mfma_f32_32x32x16_bf16 v[40:55], v[92:95], v[4:7], v[8:23]
    ds_read_b128 v[88:91], v116 offset:2048
    s_nop 15
    s_nop 7
    v_exp_f32 v24, v24
    v_exp_f32 v25, v25
    v_exp_f32 v26, v26
    v_exp_f32 v27, v27
    v_exp_f32 v28, v28
    v_mfma_f32_32x32x16_bf16 v[72:87], v[104:107], v[64:67], v[72:87]
    v_exp_f32 v29, v29
    v_exp_f32 v30, v30
    v_exp_f32 v31, v31
    v_exp_f32 v32, v32
    v_exp_f32 v33, v33
    v_mfma_f32_32x32x16_bf16 v[72:87], v[108:111], v[68:71], v[72:87]
    s_mov_b64 exec, s[44:45]
    ds_read_b128 v[96:99], v117 offset:0
    ds_read_b128 v[100:103], v117 offset:512
    s_mov_b64 exec, -1
    v_exp_f32 v34, v34
    v_exp_f32 v35, v35
    v_exp_f32 v36, v36
    v_exp_f32 v37, v37
    v_exp_f32 v38, v38
    v_exp_f32 v39, v39
    v_cvt_pk_bf16_f32 v56, v24, v25
    v_cvt_pk_bf16_f32 v57, v26, v27
    v_cvt_pk_bf16_f32 v58, v28, v29
    v_cvt_pk_bf16_f32 v59, v30, v31
    v_cvt_pk_bf16_f32 v60, v32, v33
    v_cvt_pk_bf16_f32 v61, v34, v35
    v_cvt_pk_bf16_f32 v62, v36, v37
    v_cvt_pk_bf16_f32 v63, v38, v39
    s_waitcnt lgkmcnt(0)
    v_mfma_f32_32x32x16_bf16 v[24:39], v[88:91], v[4:7], v[8:23]
    ds_read_b128 v[92:95], v116 offset:3072
    v_exp_f32 v40, v40
    v_exp_f32 v41, v41
    v_exp_f32 v42, v42
    v_exp_f32 v43, v43
    v_exp_f32 v44, v44
    v_mfma_f32_32x32x16_bf16 v[72:87], v[96:99], v[56:59], v[72:87]
    v_exp_f32 v45, v45
    v_exp_f32 v46, v46
    v_exp_f32 v47, v47
    v_exp_f32 v48, v48
    v_exp_f32 v49, v49
    v_mfma_f32_32x32x16_bf16 v[72:87], v[100:103], v[60:63], v[72:87]
    s_mov_b64 exec, s[44:45]
    ds_read_b128 v[104:107], v117 offset:1024
    ds_read_b128 v[108:111], v117 offset:1536
    s_mov_b64 exec, -1
    v_exp_f32 v50, v50
    v_exp_f32 v51, v51
    v_exp_f32 v52, v52
    v_exp_f32 v53, v53
    v_exp_f32 v54, v54
    v_exp_f32 v55, v55
    v_cvt_pk_bf16_f32 v64, v40, v41
    v_cvt_pk_bf16_f32 v65, v42, v43
    v_cvt_pk_bf16_f32 v66, v44, v45
    v_cvt_pk_bf16_f32 v67, v46, v47
    v_cvt_pk_bf16_f32 v68, v48, v49
    v_cvt_pk_bf16_f32 v69, v50, v51
    v_cvt_pk_bf16_f32 v70, v52, v53
    v_cvt_pk_bf16_f32 v71, v54, v55
    v_add_u32 v116, 2048, v116
    v_add_u32 v117, 2048, v117
    s_sub_u32 s47, s47, 1
    s_cmp_lg_u32 s47, 0
    s_cbranch_scc1 L_k2_loop
    s_waitcnt lgkmcnt(0)
    s_nop 1
    v_mfma_f32_32x32x16_bf16 v[72:87], v[104:107], v[64:67], v[72:87]
    v_mfma_f32_32x32x16_bf16 v[72:87], v[108:111], v[68:71], v[72:87]
    s_nop 15
    s_nop 3
L_k2_merge:
    s_lshr_b32 s5, s3, 1
    s_lshl_b32 s5, s5, 12
    s_add_u32 s5, s5, 131072
    v_lshlrev_b32 v114, 2, v1
    v_add_u32 v114, s5, v114
    s_cmp_eq_u32 s6, 0
    s_cbranch_scc1 L_k2_m0
    ds_write_b32 v114, v8
    ds_write_b32 v114, v72 offset:256
    ds_write_b32 v114, v73 offset:512
    ds_write_b32 v114, v74 offset:768
    ds_write_b32 v114, v75 offset:1024
    ds_write_b32 v114, v76 offset:1280
    ds_write_b32 v114, v77 offset:1536
    ds_write_b32 v114, v78 offset:1792
    ds_write_b32 v114, v79 offset:2048
    ds_write_b32 v114, v80 offset:2304
    s_waitcnt lgkmcnt(0)
    s_barrier
    s_endpgm
L_k2_m0:
    v_and_b32 v2, 31, v1
    v_lshrrev_b32 v3, 5, v1
    v_lshlrev_b32 v2, 10, v2
    v_lshl_add_u32 v2, v3, 3, v2
    s_lshr_b32 s5, s4, 5
    s_lshl_b32 s5, s5, 15
    s_and_b32 s7, s4, 31
    s_lshl_b32 s7, s7, 4
    s_add_u32 s5, s5, s7
    s_add_u32 s5, s5, 4194304
    s_add_u32 s42, s30, s5
    s_addc_u32 s43, s31, 0
    s_barrier
    ds_read_b32 v24, v114
    ds_read_b32 v25, v114 offset:256
    ds_read_b32 v26, v114 offset:512
    ds_read_b32 v27, v114 offset:768
    ds_read_b32 v28, v114 offset:1024
    ds_read_b32 v29, v114 offset:1280
    ds_read_b32 v30, v114 offset:1536
    ds_read_b32 v31, v114 offset:1792
    ds_read_b32 v32, v114 offset:2048
    ds_read_b32 v33, v114 offset:2304
    s_waitcnt lgkmcnt(0)
    v_min_f32 v114, v8, v24
    v_sub_f32 v115, v114, v8
    v_sub_f32 v116, v114, v24
    v_exp_f32 v115, v115
    v_exp_f32 v116, v116
    s_nop 0
    v_mul_f32 v72, v115, v72
    v_fma_f32 v72, v116, v25, v72
    v_mul_f32 v73, v115, v73
    v_fma_f32 v73, v116, v26, v73
    v_mul_f32 v74, v115, v74
    v_fma_f32 v74, v116, v27, v74
    v_mul_f32 v75, v115, v75
    v_fma_f32 v75, v116, v28, v75
    v_mul_f32 v76, v115, v76
    v_fma_f32 v76, v116, v29, v76
    v_mul_f32 v77, v115, v77
    v_fma_f32 v77, v116, v30, v77
    v_mul_f32 v78, v115, v78
    v_fma_f32 v78, v116, v31, v78
    v_mul_f32 v79, v115, v79
    v_fma_f32 v79, v116, v32, v79
    v_mul_f32 v80, v115, v80
    v_fma_f32 v80, v116, v33, v80
    v_mov_b32 v114, v80
    v_mov_b32 v115, v80
    s_nop 1
    v_permlane32_swap_b32 v114, v115
    s_nop 1
    v_rcp_f32 v114, v114
    s_nop 0
    v_mul_f32 v72, v114, v72
    v_mul_f32 v73, v114, v73
    v_mul_f32 v74, v114, v74
    v_mul_f32 v75, v114, v75
    v_mul_f32 v76, v114, v76
    v_mul_f32 v77, v114, v77
    v_mul_f32 v78, v114, v78
    v_mul_f32 v79, v114, v79
    v_cvt_pk_bf16_f32 v56, v72, v73
    v_cvt_pk_bf16_f32 v57, v74, v75
    v_cvt_pk_bf16_f32 v58, v76, v77
    v_cvt_pk_bf16_f32 v59, v78, v79
    s_nop 1
    v_permlane32_swap_b32 v56, v58
    v_permlane32_swap_b32 v57, v59
    v_and_b32 v2, 31, v1
    v_lshlrev_b32 v2, 10, v2
    v_lshl_add_u32 v2, v3, 9, v2
    global_store_dwordx4 v2, v[56:59], s[42:43]
L_k2_exit:
    s_endpgm

.globl k3_wo_kernel
.p2align 8
.type k3_wo_kernel,@function
k3_wo_kernel:
    s_load_dwordx16 s[8:23], s[0:1], 0
    s_load_dwordx8 s[24:31], s[0:1], 64
    s_cmp_ge_u32 s2, 256
    s_cbranch_scc1 L_k3_wo_kernel_exit
    s_lshr_b32 s5, s2, 3
    s_and_b32 s6, s2, 7
    s_lshr_b32 s3, s5, 3
    s_lshl_b32 s6, s6, 2
    s_add_u32 s3, s3, s6
    s_and_b32 s4, s5, 7
    v_and_b32 v1, 63, v0
    v_lshrrev_b32 v2, 6, v0
    s_nop 0
    v_readfirstlane_b32 s48, v2
    s_and_b32 s50, s48, 1
    s_lshr_b32 s51, s48, 1
    s_lshl_b32 s52, s48, 13
    v_lshlrev_b32 v11, 4, v1
    v_add_u32 v12, 4096, v11
    s_lshl_b32 s5, s3, 1
    s_add_u32 s5, s5, s50
    s_lshl_b32 s6, s4, 1
    s_add_u32 s6, s6, s50
    s_mul_i32 s5, s5, 32768
    s_mul_i32 s6, s6, 32768
    s_add_u32 s5, s5, 4194304
    s_add_u32 s6, s6, 16777216
    s_cmp_eq_u32 s51, 0
    s_cselect_b32 s5, s5, s6
    s_lshl_b32 s6, s50, 13
    v_add_u32 v13, s6, v11
    s_lshl_b32 s6, s51, 13
    s_add_u32 s6, s6, 16384
    v_add_u32 v14, s6, v11
    v_mov_b32 v10, 0x3f803f80
    v_mov_b32 v8, 0
    v_mov_b32 v9, 0
    s_waitcnt lgkmcnt(0)
    s_add_u32 s40, s30, s5
    s_addc_u32 s41, s31, 0
    s_mov_b32 s61, 0
    s_mov_b32 s60, 0
    s_add_u32 m0, s52, s61
    s_add_u32 s61, s61, 32768
    global_load_lds_dwordx4 v11, s[40:41] offset:0
    global_load_lds_dwordx4 v11, s[40:41] offset:1024
    global_load_lds_dwordx4 v11, s[40:41] offset:2048
    global_load_lds_dwordx4 v11, s[40:41] offset:3072
    s_add_u32 m0, m0, 4096
    s_cmp_eq_u32 s61, 163840
    s_cselect_b32 s61, 0, s61
    global_load_lds_dwordx4 v12, s[40:41] offset:0
    global_load_lds_dwordx4 v12, s[40:41] offset:1024
    global_load_lds_dwordx4 v12, s[40:41] offset:2048
    global_load_lds_dwordx4 v12, s[40:41] offset:3072
    s_add_u32 s40, s40, 8192
    s_addc_u32 s41, s41, 0
    v_and_b32 v2, 31, v1
    v_lshrrev_b32 v3, 5, v1
    v_lshlrev_b32 v24, 10, v2
    v_lshl_add_u32 v24, v3, 3, v24
    v_lshlrev_b32 v25, 4, v2
    v_lshl_add_u32 v25, v3, 3, v25
    s_lshl_b32 s5, s3, 1
    s_add_u32 s5, s5, s50
    s_lshl_b32 s6, s4, 1
    s_add_u32 s6, s6, s51
    s_lshl_b32 s7, s5, 15
    s_lshl_b32 s54, s6, 6
    s_add_u32 s7, s7, s54
    s_lshl_b32 s54, s5, 15
    s_lshl_b32 s55, s6, 11
    s_add_u32 s54, s54, s55
    s_add_u32 s54, s54, 6291456
    s_add_u32 s56, s8, s7
    s_addc_u32 s57, s9, 0
    s_add_u32 s58, s30, s54
    s_addc_u32 s59, s31, 0
    global_load_dwordx2 v[16:17], v24, s[56:57] offset:0
    global_load_dwordx2 v[18:19], v24, s[56:57] offset:16
    global_load_dwordx2 v[20:21], v24, s[56:57] offset:32
    global_load_dwordx2 v[22:23], v24, s[56:57] offset:48
    s_add_u32 m0, s52, s61
    s_add_u32 s61, s61, 32768
    global_load_lds_dwordx4 v11, s[40:41] offset:0
    global_load_lds_dwordx4 v11, s[40:41] offset:1024
    global_load_lds_dwordx4 v11, s[40:41] offset:2048
    global_load_lds_dwordx4 v11, s[40:41] offset:3072
    s_add_u32 m0, m0, 4096
    s_cmp_eq_u32 s61, 163840
    s_cselect_b32 s61, 0, s61
    global_load_lds_dwordx4 v12, s[40:41] offset:0
    global_load_lds_dwordx4 v12, s[40:41] offset:1024
    global_load_lds_dwordx4 v12, s[40:41] offset:2048
    global_load_lds_dwordx4 v12, s[40:41] offset:3072
    s_add_u32 s40, s40, 8192
    s_addc_u32 s41, s41, 0
    v_mov_b32 v32, 0
    v_mov_b32 v33, 0
    v_mov_b32 v34, 0
    v_mov_b32 v35, 0
    v_mov_b32 v36, 0
    v_mov_b32 v37, 0
    v_mov_b32 v38, 0
    v_mov_b32 v39, 0
    v_mov_b32 v40, 0
    v_mov_b32 v41, 0
    v_mov_b32 v42, 0
    v_mov_b32 v43, 0
    v_mov_b32 v44, 0
    v_mov_b32 v45, 0
    v_mov_b32 v46, 0
    v_mov_b32 v47, 0
    s_mov_b32 s62, 3
    s_mov_b32 s63, 0
L_k3_wo_kernel_loop:
    s_waitcnt vmcnt(8)
    s_barrier
    s_cmp_lt_u32 s62, 2
    s_cbranch_scc1 L_k3_wo_kernel_noiss
    s_add_u32 m0, s52, s61
    s_add_u32 s61, s61, 32768
    global_load_lds_dwordx4 v11, s[40:41] offset:0
    global_load_lds_dwordx4 v11, s[40:41] offset:1024
    global_load_lds_dwordx4 v11, s[40:41] offset:2048
    global_load_lds_dwordx4 v11, s[40:41] offset:3072
    s_add_u32 m0, m0, 4096
    s_cmp_eq_u32 s61, 163840
    s_cselect_b32 s61, 0, s61
    global_load_lds_dwordx4 v12, s[40:41] offset:0
    global_load_lds_dwordx4 v12, s[40:41] offset:1024
    global_load_lds_dwordx4 v12, s[40:41] offset:2048
    global_load_lds_dwordx4 v12, s[40:41] offset:3072
    s_add_u32 s40, s40, 8192
    s_addc_u32 s41, s41, 0
L_k3_wo_kernel_noiss:
    v_add_u32 v2, s60, v13
    v_add_u32 v3, s60, v14
    ds_read_b128 v[64:67], v2 offset:0
    ds_read_b128 v[68:71], v3 offset:0
    ds_read_b128 v[72:75], v2 offset:1024
    ds_read_b128 v[76:79], v3 offset:1024
    ds_read_b128 v[80:83], v2 offset:2048
    ds_read_b128 v[84:87], v3 offset:2048
    ds_read_b128 v[88:91], v2 offset:3072
    ds_read_b128 v[92:95], v3 offset:3072
    ds_read_b128 v[96:99], v2 offset:4096
    ds_read_b128 v[100:103], v3 offset:4096
    ds_read_b128 v[104:107], v2 offset:5120
    ds_read_b128 v[108:111], v3 offset:5120
    s_add_u32 s60, s60, 32768
    s_cmp_eq_u32 s60, 163840
    s_cselect_b32 s60, 0, s60
    ds_read_b128 v[112:115], v2 offset:6144
    ds_read_b128 v[116:119], v3 offset:6144
    s_waitcnt lgkmcnt(12)
    v_mfma_f32_32x32x16_bf16 v[32:47], v[68:71], v[64:67], v[32:47]
    ds_read_b128 v[120:123], v2 offset:7168
    ds_read_b128 v[124:127], v3 offset:7168
    s_waitcnt lgkmcnt(12)
    v_mfma_f32_32x32x16_bf16 v[32:47], v[76:79], v[72:75], v[32:47]
    s_waitcnt lgkmcnt(10)
    v_mfma_f32_32x32x16_bf16 v[32:47], v[84:87], v[80:83], v[32:47]
    s_waitcnt lgkmcnt(8)
    v_mfma_f32_32x32x16_bf16 v[32:47], v[92:95], v[88:91], v[32:47]
    s_waitcnt lgkmcnt(6)
    v_mfma_f32_32x32x16_bf16 v[32:47], v[100:103], v[96:99], v[32:47]
    s_waitcnt lgkmcnt(4)
    v_mfma_f32_32x32x16_bf16 v[32:47], v[108:111], v[104:107], v[32:47]
    s_waitcnt lgkmcnt(2)
    v_mfma_f32_32x32x16_bf16 v[32:47], v[116:119], v[112:115], v[32:47]
    s_waitcnt lgkmcnt(0)
    v_mfma_f32_32x32x16_bf16 v[32:47], v[124:127], v[120:123], v[32:47]
    s_sub_u32 s62, s62, 1
    s_cmp_lg_u32 s62, 0
    s_cbranch_scc1 L_k3_wo_kernel_loop
    s_waitcnt vmcnt(0)
    s_barrier
    v_add_u32 v2, s60, v13
    v_add_u32 v3, s60, v14
    ds_read_b128 v[64:67], v2 offset:0
    ds_read_b128 v[68:71], v3 offset:0
    ds_read_b128 v[72:75], v2 offset:1024
    ds_read_b128 v[76:79], v3 offset:1024
    ds_read_b128 v[80:83], v2 offset:2048
    ds_read_b128 v[84:87], v3 offset:2048
    ds_read_b128 v[88:91], v2 offset:3072
    ds_read_b128 v[92:95], v3 offset:3072
    ds_read_b128 v[96:99], v2 offset:4096
    ds_read_b128 v[100:103], v3 offset:4096
    ds_read_b128 v[104:107], v2 offset:5120
    ds_read_b128 v[108:111], v3 offset:5120
    s_add_u32 s60, s60, 32768
    s_cmp_eq_u32 s60, 163840
    s_cselect_b32 s60, 0, s60
    ds_read_b128 v[112:115], v2 offset:6144
    ds_read_b128 v[116:119], v3 offset:6144
    s_waitcnt lgkmcnt(12)
    v_mfma_f32_32x32x16_bf16 v[32:47], v[68:71], v[64:67], v[32:47]
    ds_read_b128 v[120:123], v2 offset:7168
    ds_read_b128 v[124:127], v3 offset:7168
    s_waitcnt lgkmcnt(12)
    v_mfma_f32_32x32x16_bf16 v[32:47], v[76:79], v[72:75], v[32:47]
    s_waitcnt lgkmcnt(10)
    v_mfma_f32_32x32x16_bf16 v[32:47], v[84:87], v[80:83], v[32:47]
    s_waitcnt lgkmcnt(8)
    v_mfma_f32_32x32x16_bf16 v[32:47], v[92:95], v[88:91], v[32:47]
    s_waitcnt lgkmcnt(6)
    v_mfma_f32_32x32x16_bf16 v[32:47], v[100:103], v[96:99], v[32:47]
    s_waitcnt lgkmcnt(4)
    v_mfma_f32_32x32x16_bf16 v[32:47], v[108:111], v[104:107], v[32:47]
    s_waitcnt lgkmcnt(2)
    v_mfma_f32_32x32x16_bf16 v[32:47], v[116:119], v[112:115], v[32:47]
    s_waitcnt lgkmcnt(0)
    v_mfma_f32_32x32x16_bf16 v[32:47], v[124:127], v[120:123], v[32:47]
    s_nop 15
    s_nop 7
L_k3_wo_kernel_epi:
    v_lshlrev_b32 v2, 16, v16
    v_and_b32 v3, 0xffff0000, v16
    v_add_f32 v32, v32, v2
    v_add_f32 v33, v33, v3
    v_lshlrev_b32 v2, 16, v17
    v_and_b32 v3, 0xffff0000, v17
    v_add_f32 v34, v34, v2
    v_add_f32 v35, v35, v3
    v_lshlrev_b32 v2, 16, v18
    v_and_b32 v3, 0xffff0000, v18
    v_add_f32 v36, v36, v2
    v_add_f32 v37, v37, v3
    v_lshlrev_b32 v2, 16, v19
    v_and_b32 v3, 0xffff0000, v19
    v_add_f32 v38, v38, v2
    v_add_f32 v39, v39, v3
    v_lshlrev_b32 v2, 16, v20
    v_and_b32 v3, 0xffff0000, v20
    v_add_f32 v40, v40, v2
    v_add_f32 v41, v41, v3
    v_lshlrev_b32 v2, 16, v21
    v_and_b32 v3, 0xffff0000, v21
    v_add_f32 v42, v42, v2
    v_add_f32 v43, v43, v3
    v_lshlrev_b32 v2, 16, v22
    v_and_b32 v3, 0xffff0000, v22
    v_add_f32 v44, v44, v2
    v_add_f32 v45, v45, v3
    v_lshlrev_b32 v2, 16, v23
    v_and_b32 v3, 0xffff0000, v23
    v_add_f32 v46, v46, v2
    v_add_f32 v47, v47, v3
    v_cvt_pk_bf16_f32 v48, v32, v33
    v_cvt_pk_bf16_f32 v49, v34, v35
    v_cvt_pk_bf16_f32 v50, v36, v37
    v_cvt_pk_bf16_f32 v51, v38, v39
    v_cvt_pk_bf16_f32 v52, v40, v41
    v_cvt_pk_bf16_f32 v53, v42, v43
    v_cvt_pk_bf16_f32 v54, v44, v45
    v_cvt_pk_bf16_f32 v55, v46, v47
    v_lshrrev_b32 v2, 5, v1
    v_lshlrev_b32 v3, 4, v1
    v_permlane32_swap_b32 v48, v50
    v_permlane32_swap_b32 v49, v51
    v_permlane32_swap_b32 v52, v54
    v_permlane32_swap_b32 v53, v55
    s_nop 1
    global_store_dwordx4 v3, v[48:51], s[58:59] offset:0
    global_store_dwordx4 v3, v[52:55], s[58:59] offset:1024
    s_nop 0
    v_dot2c_f32_bf16 v8, v48, v10
    v_dot2c_f32_bf16 v9, v48, v48
    v_dot2c_f32_bf16 v8, v49, v10
    v_dot2c_f32_bf16 v9, v49, v49
    v_dot2c_f32_bf16 v8, v50, v10
    v_dot2c_f32_bf16 v9, v50, v50
    v_dot2c_f32_bf16 v8, v51, v10
    v_dot2c_f32_bf16 v9, v51, v51
    v_dot2c_f32_bf16 v8, v52, v10
    v_dot2c_f32_bf16 v9, v52, v52
    v_dot2c_f32_bf16 v8, v53, v10
    v_dot2c_f32_bf16 v9, v53, v53
    v_dot2c_f32_bf16 v8, v54, v10
    v_dot2c_f32_bf16 v9, v54, v54
    v_dot2c_f32_bf16 v8, v55, v10
    v_dot2c_f32_bf16 v9, v55, v55
    v_mov_b32 v2, v8
    v_mov_b32 v3, v9
    s_nop 1
    v_permlane32_swap_b32 v8, v2
    v_permlane32_swap_b32 v9, v3
    s_nop 1
    v_add_f32 v8, v8, v2
    v_add_f32 v9, v9, v3
    v_and_b32 v2, 31, v1
    v_lshlrev_b32 v2, 7, v2
    s_lshl_b32 s64, s5, 12
    s_lshl_b32 s65, s6, 3
    s_add_u32 s64, s64, s65
    s_add_u32 s64, s64, 8388608
    s_add_u32 s66, s30, s64
    s_addc_u32 s67, s31, 0
    v_cmp_gt_u32 vcc, 32, v1
    s_and_saveexec_b64 s[54:55], vcc
    global_store_dwordx2 v2, v[8:9], s[66:67]
    s_mov_b64 exec, -1
L_k3_wo_kernel_exit:
    s_endpgm

.globl k4_ffn_kernel
.p2align 8
.type k4_ffn_kernel,@function
k4_ffn_kernel:
    s_load_dwordx16 s[8:23], s[0:1], 0
    s_load_dwordx8 s[24:31], s[0:1], 64
    s_and_b32 s6, s2, 7
    s_lshr_b32 s5, s2, 3
    s_mul_i32 s6, s6, 31
    s_add_u32 s5, s5, s6
    s_cmp_ge_u32 s2, 248
    s_cbranch_scc1 L_k4_exit
    s_cmp_ge_u32 s5, 242
    s_cbranch_scc1 L_k4_exit
    s_mul_i32 s3, s5, 10923
    s_lshr_b32 s3, s3, 16
    s_mul_i32 s4, s3, 6
    s_sub_u32 s4, s5, s4
    s_sub_u32 s7, s5, 132
    s_mul_i32 s6, s7, 13108
    s_lshr_b32 s6, s6, 16
    s_mul_i32 s49, s6, 5
    s_sub_u32 s49, s7, s49
    s_add_u32 s49, s49, 6
    s_cmp_lt_u32 s5, 132
    s_cselect_b32 s3, s3, s6
    s_cselect_b32 s4, s4, s49
    v_and_b32 v1, 63, v0
    v_lshrrev_b32 v2, 6, v0
    s_nop 0
    v_readfirstlane_b32 s48, v2
    s_lshl_b32 s4, s4, 2
    s_add_u32 s4, s4, s48
    s_min_u32 s49, s4, 42
    s_mul_i32 s3, s3, 3
    v_lshlrev_b32 v10, 4, v1
    v_add_u32 v11, 4096, v10
    v_add_u32 v12, 8192, v10
    v_add_u32 v13, 12288, v10
    v_add_u32 v14, 16384, v10
    v_add_u32 v15, 20480, v10
    v_add_u32 v16, 24576, v10
    v_add_u32 v17, 28672, v10
    v_add_u32 v19, 65536, v10
    s_add_u32 s60, s3, 0
    s_min_u32 s60, s60, 63
    s_add_u32 s61, s3, 1
    s_min_u32 s61, s61, 63
    s_add_u32 s62, s3, 2
    s_min_u32 s62, s62, 63
    s_lshl_b32 s52, s48, 11
    s_waitcnt lgkmcnt(0)
    s_lshl_b32 s5, s60, 15
    s_add_u32 s5, s5, s52
    s_add_u32 s5, s5, 6291456
    s_add_u32 s64, s30, s5
    s_addc_u32 s65, s31, 0
    s_lshl_b32 s5, s61, 15
    s_add_u32 s5, s5, s52
    s_add_u32 s5, s5, 6291456
    s_add_u32 s66, s30, s5
    s_addc_u32 s67, s31, 0
    s_lshl_b32 s5, s62, 15
    s_add_u32 s5, s5, s52
    s_add_u32 s5, s5, 6291456
    s_add_u32 s68, s30, s5
    s_addc_u32 s69, s31, 0
    s_lshl_b32 s5, s49, 15
    s_add_u32 s6, s5, 17825792
    s_add_u32 s40, s30, s6
    s_addc_u32 s41, s31, 0
    s_add_u32 s6, s5, 19922944
    s_add_u32 s42, s30, s6
    s_addc_u32 s43, s31, 0
    s_add_u32 m0, s52, 0
    s_nop 0
    global_load_lds_dwordx4 v10, s[64:65]
    global_load_lds_dwordx4 v10, s[64:65] offset:1024
    s_add_u32 m0, s52, 32768
    s_nop 0
    global_load_lds_dwordx4 v10, s[66:67]
    global_load_lds_dwordx4 v10, s[66:67] offset:1024
    s_add_u32 m0, s52, 65536
    s_nop 0
    global_load_lds_dwordx4 v10, s[68:69]
    global_load_lds_dwordx4 v10, s[68:69] offset:1024
    global_load_dwordx4 v[148:151], v10, s[40:41] offset:0
    global_load_dwordx4 v[152:155], v10, s[42:43] offset:0
    global_load_dwordx4 v[156:159], v10, s[40:41] offset:1024
    global_load_dwordx4 v[160:163], v10, s[42:43] offset:1024
    global_load_dwordx4 v[164:167], v10, s[40:41] offset:2048
    global_load_dwordx4 v[168:171], v10, s[42:43] offset:2048
    global_load_dwordx4 v[172:175], v10, s[40:41] offset:3072
    global_load_dwordx4 v[176:179], v10, s[42:43] offset:3072
    s_add_u32 m0, s52, 8192
    s_nop 0
    global_load_lds_dwordx4 v12, s[64:65]
    global_load_lds_dwordx4 v12, s[64:65] offset:1024
    s_add_u32 m0, s52, 40960
    s_nop 0
    global_load_lds_dwordx4 v12, s[66:67]
    global_load_lds_dwordx4 v12, s[66:67] offset:1024
    s_add_u32 m0, s52, 73728
    s_nop 0
    global_load_lds_dwordx4 v12, s[68:69]
    global_load_lds_dwordx4 v12, s[68:69] offset:1024
    global_load_dwordx4 v[180:183], v11, s[40:41] offset:0
    global_load_dwordx4 v[184:187], v11, s[42:43] offset:0
    global_load_dwordx4 v[188:191], v11, s[40:41] offset:1024
    global_load_dwordx4 v[192:195], v11, s[42:43] offset:1024
    s_waitcnt vmcnt(18)
    s_barrier
    ds_read_b128 v[28:31], v10 offset:0
    ds_read_b128 v[32:35], v10 offset:32768
    ds_read_b128 v[36:39], v19 offset:0
    ds_read_b128 v[40:43], v10 offset:1024
    ds_read_b128 v[44:47], v10 offset:33792
    ds_read_b128 v[48:51], v19 offset:1024
    s_waitcnt vmcnt(16) lgkmcnt(3)
    v_mfma_f32_32x32x16_bf16 v[52:67], v[148:151], v[28:31], 0
    v_mfma_f32_32x32x16_bf16 v[68:83], v[152:155], v[28:31], 0
    v_mfma_f32_32x32x16_bf16 v[84:99], v[148:151], v[32:35], 0
    v_mfma_f32_32x32x16_bf16 v[100:115], v[152:155], v[32:35], 0
    v_mfma_f32_32x32x16_bf16 v[116:131], v[148:151], v[36:39], 0
    v_mfma_f32_32x32x16_bf16 v[132:147], v[152:155], v[36:39], 0
    global_load_dwordx4 v[196:199], v11, s[40:41] offset:2048
    global_load_dwordx4 v[200:203], v11, s[42:43] offset:2048
    global_load_dwordx4 v[204:207], v11, s[40:41] offset:3072
    global_load_dwordx4 v[208:211], v11, s[42:43] offset:3072
    ds_read_b128 v[28:31], v10 offset:2048
    ds_read_b128 v[32:35], v10 offset:34816
    ds_read_b128 v[36:39], v19 offset:2048
    s_waitcnt vmcnt(18) lgkmcnt(3)
    v_mfma_f32_32x32x16_bf16 v[52:67], v[156:159], v[40:43], v[52:67]
    v_mfma_f32_32x32x16_bf16 v[68:83], v[160:163], v[40:43], v[68:83]
    v_mfma_f32_32x32x16_bf16 v[84:99], v[156:159], v[44:47], v[84:99]
    v_mfma_f32_32x32x16_bf16 v[100:115], v[160:163], v[44:47], v[100:115]
    v_mfma_f32_32x32x16_bf16 v[116:131], v[156:159], v[48:51], v[116:131]
    v_mfma_f32_32x32x16_bf16 v[132:147], v[160:163], v[48:51], v[132:147]
    global_load_dwordx4 v[212:215], v12, s[40:41] offset:0
    global_load_dwordx4 v[216:219], v12, s[42:43] offset:0
    global_load_dwordx4 v[220:223], v12, s[40:41] offset:1024
    global_load_dwordx4 v[224:227], v12, s[42:43] offset:1024
    ds_read_b128 v[40:43], v10 offset:3072
    ds_read_b128 v[44:47], v10 offset:35840
    ds_read_b128 v[48:51], v19 offset:3072
    s_waitcnt vmcnt(20) lgkmcnt(3)
    v_mfma_f32_32x32x16_bf16 v[52:67], v[164:167], v[28:31], v[52:67]
    v_mfma_f32_32x32x16_bf16 v[68:83], v[168:171], v[28:31], v[68:83]
    v_mfma_f32_32x32x16_bf16 v[84:99], v[164:167], v[32:35], v[84:99]
    v_mfma_f32_32x32x16_bf16 v[100:115], v[168:171], v[32:35], v[100:115]
    v_mfma_f32_32x32x16_bf16 v[116:131], v[164:167], v[36:39], v[116:131]
    v_mfma_f32_32x32x16_bf16 v[132:147], v[168:171], v[36:39], v[132:147]
    s_add_u32 m0, s52, 16384
    s_nop 0
    global_load_lds_dwordx4 v14, s[64:65]
    global_load_lds_dwordx4 v14, s[64:65] offset:1024
    s_add_u32 m0, s52, 49152
    s_nop 0
    global_load_lds_dwordx4 v14, s[66:67]
    global_load_lds_dwordx4 v14, s[66:67] offset:1024
    s_add_u32 m0, s52, 81920
    s_nop 0
    global_load_lds_dwordx4 v14, s[68:69]
    global_load_lds_dwordx4 v14, s[68:69] offset:1024
    global_load_dwordx4 v[228:231], v12, s[40:41] offset:2048
    global_load_dwordx4 v[232:235], v12, s[42:43] offset:2048
    ds_read_b128 v[28:31], v10 offset:4096
    ds_read_b128 v[32:35], v10 offset:36864
    ds_read_b128 v[36:39], v19 offset:4096
    s_waitcnt vmcnt(26) lgkmcnt(3)
    v_mfma_f32_32x32x16_bf16 v[52:67], v[172:175], v[40:43], v[52:67]
    v_mfma_f32_32x32x16_bf16 v[68:83], v[176:179], v[40:43], v[68:83]
    v_mfma_f32_32x32x16_bf16 v[84:99], v[172:175], v[44:47], v[84:99]
    v_mfma_f32_32x32x16_bf16 v[100:115], v[176:179], v[44:47], v[100:115]
    v_mfma_f32_32x32x16_bf16 v[116:131], v[172:175], v[48:51], v[116:131]
    v_mfma_f32_32x32x16_bf16 v[132:147], v[176:179], v[48:51], v[132:147]
    global_load_dwordx4 v[236:239], v12, s[40:41] offset:3072
    global_load_dwordx4 v[240:243], v12, s[42:43] offset:3072
    global_load_dwordx4 v[148:151], v13, s[40:41] offset:0
    global_load_dwordx4 v[152:155], v13, s[42:43] offset:0
    ds_read_b128 v[40:43], v10 offset:5120
    ds_read_b128 v[44:47], v10 offset:37888
    ds_read_b128 v[48:51], v19 offset:5120
    s_waitcnt vmcnt(22) lgkmcnt(3)
    v_mfma_f32_32x32x16_bf16 v[52:67], v[180:183], v[28:31], v[52:67]
    v_mfma_f32_32x32x16_bf16 v[68:83], v[184:187], v[28:31], v[68:83]
    v_mfma_f32_32x32x16_bf16 v[84:99], v[180:183], v[32:35], v[84:99]
    v_mfma_f32_32x32x16_bf16 v[100:115], v[184:187], v[32:35], v[100:115]
    v_mfma_f32_32x32x16_bf16 v[116:131], v[180:183], v[36:39], v[116:131]
    v_mfma_f32_32x32x16_bf16 v[132:147], v[184:187], v[36:39], v[132:147]
    global_load_dwordx4 v[156:159], v13, s[40:41] offset:1024
    global_load_dwordx4 v[160:163], v13, s[42:43] offset:1024
    global_load_dwordx4 v[164:167], v13, s[40:41] offset:2048
    global_load_dwordx4 v[168:171], v13, s[42:43] offset:2048
    ds_read_b128 v[28:31], v10 offset:6144
    ds_read_b128 v[32:35], v10 offset:38912
    ds_read_b128 v[36:39], v19 offset:6144
    s_waitcnt vmcnt(24) lgkmcnt(3)
    v_mfma_f32_32x32x16_bf16 v[52:67], v[188:191], v[40:43], v[52:67]
    v_mfma_f32_32x32x16_bf16 v[68:83], v[192:195], v[40:43], v[68:83]
    v_mfma_f32_32x32x16_bf16 v[84:99], v[188:191], v[44:47], v[84:99]
    v_mfma_f32_32x32x16_bf16 v[100:115], v[192:195], v[44:47], v[100:115]
    v_mfma_f32_32x32x16_bf16 v[116:131], v[188:191], v[48:51], v[116:131]
    v_mfma_f32_32x32x16_bf16 v[132:147], v[192:195], v[48:51], v[132:147]
    global_load_dwordx4 v[172:175], v13, s[40:41] offset:3072
    global_load_dwordx4 v[176:179], v13, s[42:43] offset:3072
    global_load_dwordx4 v[180:183], v14, s[40:41] offset:0
    global_load_dwordx4 v[184:187], v14, s[42:43] offset:0
    ds_read_b128 v[40:43], v10 offset:7168
    ds_read_b128 v[44:47], v10 offset:39936
    ds_read_b128 v[48:51], v19 offset:7168
    s_waitcnt vmcnt(26) lgkmcnt(3)
    v_mfma_f32_32x32x16_bf16 v[52:67], v[196:199], v[28:31], v[52:67]
    v_mfma_f32_32x32x16_bf16 v[68:83], v[200:203], v[28:31], v[68:83]
    v_mfma_f32_32x32x16_bf16 v[84:99], v[196:199], v[32:35], v[84:99]
    v_mfma_f32_32x32x16_bf16 v[100:115], v[200:203], v[32:35], v[100:115]
    v_mfma_f32_32x32x16_bf16 v[116:131], v[196:199], v[36:39], v[116:131]
    v_mfma_f32_32x32x16_bf16 v[132:147], v[200:203], v[36:39], v[132:147]
    global_load_dwordx4 v[188:191], v14, s[40:41] offset:1024
    global_load_dwordx4 v[192:195], v14, s[42:43] offset:1024
    global_load_dwordx4 v[196:199], v14, s[40:41] offset:2048
    global_load_dwordx4 v[200:203], v14, s[42:43] offset:2048
    s_waitcnt vmcnt(28) lgkmcnt(0)
    v_mfma_f32_32x32x16_bf16 v[52:67], v[204:207], v[40:43], v[52:67]
    v_mfma_f32_32x32x16_bf16 v[68:83], v[208:211], v[40:43], v[68:83]
    v_mfma_f32_32x32x16_bf16 v[84:99], v[204:207], v[44:47], v[84:99]
    v_mfma_f32_32x32x16_bf16 v[100:115], v[208:211], v[44:47], v[100:115]
    v_mfma_f32_32x32x16_bf16 v[116:131], v[204:207], v[48:51], v[116:131]
    v_mfma_f32_32x32x16_bf16 v[132:147], v[208:211], v[48:51], v[132:147]
    global_load_dwordx4 v[204:207], v14, s[40:41] offset:3072
    global_load_dwordx4 v[208:211], v14, s[42:43] offset:3072
    s_waitcnt vmcnt(28) lgkmcnt(0)
    s_barrier
    ds_read_b128 v[28:31], v10 offset:8192
    ds_read_b128 v[32:35], v10 offset:40960
    ds_read_b128 v[36:39], v19 offset:8192
    ds_read_b128 v[40:43], v10 offset:9216
    ds_read_b128 v[44:47], v10 offset:41984
    ds_read_b128 v[48:51], v19 offset:9216
    s_waitcnt vmcnt(28) lgkmcnt(3)
    v_mfma_f32_32x32x16_bf16 v[52:67], v[212:215], v[28:31], v[52:67]
    v_mfma_f32_32x32x16_bf16 v[68:83], v[216:219], v[28:31], v[68:83]
    v_mfma_f32_32x32x16_bf16 v[84:99], v[212:215], v[32:35], v[84:99]
    v_mfma_f32_32x32x16_bf16 v[100:115], v[216:219], v[32:35], v[100:115]
    v_mfma_f32_32x32x16_bf16 v[116:131], v[212:215], v[36:39], v[116:131]
    v_mfma_f32_32x32x16_bf16 v[132:147], v[216:219], v[36:39], v[132:147]
    global_load_dwordx4 v[212:215], v15, s[40:41] offset:0
    global_load_dwordx4 v[216:219], v15, s[42:43] offset:0
    ds_read_b128 v[28:31], v10 offset:10240
    ds_read_b128 v[32:35], v10 offset:43008
    ds_read_b128 v[36:39], v19 offset:10240
    s_waitcnt vmcnt(28) lgkmcnt(3)
    v_mfma_f32_32x32x16_bf16 v[52:67], v[220:223], v[40:43], v[52:67]
    v_mfma_f32_32x32x16_bf16 v[68:83], v[224:227], v[40:43], v[68:83]
    v_mfma_f32_32x32x16_bf16 v[84:99], v[220:223], v[44:47], v[84:99]
    v_mfma_f32_32x32x16_bf16 v[100:115], v[224:227], v[44:47], v[100:115]
    v_mfma_f32_32x32x16_bf16 v[116:131], v[220:223], v[48:51], v[116:131]
    v_mfma_f32_32x32x16_bf16 v[132:147], v[224:227], v[48:51], v[132:147]
    global_load_dwordx4 v[220:223], v15, s[40:41] offset:1024
    global_load_dwordx4 v[224:227], v15, s[42:43] offset:1024
    ds_read_b128 v[40:43], v10 offset:11264
    ds_read_b128 v[44:47], v10 offset:44032
    ds_read_b128 v[48:51], v19 offset:11264
    s_waitcnt vmcnt(22) lgkmcnt(3)
    v_mfma_f32_32x32x16_bf16 v[52:67], v[228:231], v[28:31], v[52:67]
    v_mfma_f32_32x32x16_bf16 v[68:83], v[232:235], v[28:31], v[68:83]
    v_mfma_f32_32x32x16_bf16 v[84:99], v[228:231], v[32:35], v[84:99]
    v_mfma_f32_32x32x16_bf16 v[100:115], v[232:235], v[32:35], v[100:115]
    v_mfma_f32_32x32x16_bf16 v[116:131], v[228:231], v[36:39], v[116:131]
    v_mfma_f32_32x32x16_bf16 v[132:147], v[232:235], v[36:39], v[132:147]
    s_add_u32 m0, s52, 24576
    s_nop 0
    global_load_lds_dwordx4 v16, s[64:65]
    global_load_lds_dwordx4 v16, s[64:65] offset:1024
    s_add_u32 m0, s52, 57344
    s_nop 0
    global_load_lds_dwordx4 v16, s[66:67]
    global_load_lds_dwordx4 v16, s[66:67] offset:1024
    s_add_u32 m0, s52, 90112
    s_nop 0
    global_load_lds_dwordx4 v16, s[68:69]
    global_load_lds_dwordx4 v16, s[68:69] offset:1024
    global_load_dwordx4 v[228:231], v15, s[40:41] offset:2048
    global_load_dwordx4 v[232:235], v15, s[42:43] offset:2048
    ds_read_b128 v[28:31], v10 offset:12288
    ds_read_b128 v[32:35], v10 offset:45056
    ds_read_b128 v[36:39], v19 offset:12288
    s_waitcnt vmcnt(28) lgkmcnt(3)
    v_mfma_f32_32x32x16_bf16 v[52:67], v[236:239], v[40:43], v[52:67]
    v_mfma_f32_32x32x16_bf16 v[68:83], v[240:243], v[40:43], v[68:83]
    v_mfma_f32_32x32x16_bf16 v[84:99], v[236:239], v[44:47], v[84:99]
    v_mfma_f32_32x32x16_bf16 v[100:115], v[240:243], v[44:47], v[100:115]
    v_mfma_f32_32x32x16_bf16 v[116:131], v[236:239], v[48:51], v[116:131]
    v_mfma_f32_32x32x16_bf16 v[132:147], v[240:243], v[48:51], v[132:147]
    global_load_dwordx4 v[236:239], v15, s[40:41] offset:3072
    global_load_dwordx4 v[240:243], v15, s[42:43] offset:3072
    ds_read_b128 v[40:43], v10 offset:13312
    ds_read_b128 v[44:47], v10 offset:46080
    ds_read_b128 v[48:51], v19 offset:13312
    s_waitcnt vmcnt(28) lgkmcnt(3)
    v_mfma_f32_32x32x16_bf16 v[52:67], v[148:151], v[28:31], v[52:67]
    v_mfma_f32_32x32x16_bf16 v[68:83], v[152:155], v[28:31], v[68:83]
    v_mfma_f32_32x32x16_bf16 v[84:99], v[148:151], v[32:35], v[84:99]
    v_mfma_f32_32x32x16_bf16 v[100:115], v[152:155], v[32:35], v[100:115]
    v_mfma_f32_32x32x16_bf16 v[116:131], v[148:151], v[36:39], v[116:131]
    v_mfma_f32_32x32x16_bf16 v[132:147], v[152:155], v[36:39], v[132:147]
    global_load_dwordx4 v[148:151], v16, s[40:41] offset:0
    global_load_dwordx4 v[152:155], v16, s[42:43] offset:0
    ds_read_b128 v[28:31], v10 offset:14336
    ds_read_b128 v[32:35], v10 offset:47104
    ds_read_b128 v[36:39], v19 offset:14336
    s_waitcnt vmcnt(28) lgkmcnt(3)
    v_mfma_f32_32x32x16_bf16 v[52:67], v[156:159], v[40:43], v[52:67]
    v_mfma_f32_32x32x16_bf16 v[68:83], v[160:163], v[40:43], v[68:83]
    v_mfma_f32_32x32x16_bf16 v[84:99], v[156:159], v[44:47], v[84:99]
    v_mfma_f32_32x32x16_bf16 v[100:115], v[160:163], v[44:47], v[100:115]
    v_mfma_f32_32x32x16_bf16 v[116:131], v[156:159], v[48:51], v[116:131]
    v_mfma_f32_32x32x16_bf16 v[132:147], v[160:163], v[48:51], v[132:147]
    global_load_dwordx4 v[156:159], v16, s[40:41] offset:1024
    global_load_dwordx4 v[160:163], v16, s[42:43] offset:1024
    ds_read_b128 v[40:43], v10 offset:15360
    ds_read_b128 v[44:47], v10 offset:48128
    ds_read_b128 v[48:51], v19 offset:15360
    s_waitcnt vmcnt(28) lgkmcnt(3)
    v_mfma_f32_32x32x16_bf16 v[52:67], v[164:167], v[28:31], v[52:67]
    v_mfma_f32_32x32x16_bf16 v[68:83], v[168:171], v[28:31], v[68:83]
    v_mfma_f32_32x32x16_bf16 v[84:99], v[164:167], v[32:35], v[84:99]
    v_mfma_f32_32x32x16_bf16 v[100:115], v[168:171], v[32:35], v[100:115]
    v_mfma_f32_32x32x16_bf16 v[116:131], v[164:167], v[36:39], v[116:131]
    v_mfma_f32_32x32x16_bf16 v[132:147], v[168:171], v[36:39], v[132:147]
    global_load_dwordx4 v[164:167], v16, s[40:41] offset:2048
    global_load_dwordx4 v[168:171], v16, s[42:43] offset:2048
    s_waitcnt vmcnt(28) lgkmcnt(0)
    v_mfma_f32_32x32x16_bf16 v[52:67], v[172:175], v[40:43], v[52:67]
    v_mfma_f32_32x32x16_bf16 v[68:83], v[176:179], v[40:43], v[68:83]
    v_mfma_f32_32x32x16_bf16 v[84:99], v[172:175], v[44:47], v[84:99]
    v_mfma_f32_32x32x16_bf16 v[100:115], v[176:179], v[44:47], v[100:115]
    v_mfma_f32_32x32x16_bf16 v[116:131], v[172:175], v[48:51], v[116:131]
    v_mfma_f32_32x32x16_bf16 v[132:147], v[176:179], v[48:51], v[132:147]
    global_load_dwordx4 v[172:175], v16, s[40:41] offset:3072
    global_load_dwordx4 v[176:179], v16, s[42:43] offset:3072
    s_waitcnt vmcnt(28) lgkmcnt(0)
    s_barrier
    ds_read_b128 v[28:31], v10 offset:16384
    ds_read_b128 v[32:35], v10 offset:49152
    ds_read_b128 v[36:39], v19 offset:16384
    ds_read_b128 v[40:43], v10 offset:17408
    ds_read_b128 v[44:47], v10 offset:50176
    ds_read_b128 v[48:51], v19 offset:17408
    s_waitcnt vmcnt(28) lgkmcnt(3)
    v_mfma_f32_32x32x16_bf16 v[52:67], v[180:183], v[28:31], v[52:67]
    v_mfma_f32_32x32x16_bf16 v[68:83], v[184:187], v[28:31], v[68:83]
    v_mfma_f32_32x32x16_bf16 v[84:99], v[180:183], v[32:35], v[84:99]
    v_mfma_f32_32x32x16_bf16 v[100:115], v[184:187], v[32:35], v[100:115]
    v_mfma_f32_32x32x16_bf16 v[116:131], v[180:183], v[36:39], v[116:131]
    v_mfma_f32_32x32x16_bf16 v[132:147], v[184:187], v[36:39], v[132:147]
    global_load_dwordx4 v[180:183], v17, s[40:41] offset:0
    global_load_dwordx4 v[184:187], v17, s[42:43] offset:0
    ds_read_b128 v[28:31], v10 offset:18432
    ds_read_b128 v[32:35], v10 offset:51200
    ds_read_b128 v[36:39], v19 offset:18432
    s_waitcnt vmcnt(28) lgkmcnt(3)
    v_mfma_f32_32x32x16_bf16 v[52:67], v[188:191], v[40:43], v[52:67]
    v_mfma_f32_32x32x16_bf16 v[68:83], v[192:195], v[40:43], v[68:83]
    v_mfma_f32_32x32x16_bf16 v[84:99], v[188:191], v[44:47], v[84:99]
    v_mfma_f32_32x32x16_bf16 v[100:115], v[192:195], v[44:47], v[100:115]
    v_mfma_f32_32x32x16_bf16 v[116:131], v[188:191], v[48:51], v[116:131]
    v_mfma_f32_32x32x16_bf16 v[132:147], v[192:195], v[48:51], v[132:147]
    global_load_dwordx4 v[188:191], v17, s[40:41] offset:1024
    global_load_dwordx4 v[192:195], v17, s[42:43] offset:1024
    ds_read_b128 v[40:43], v10 offset:19456
    ds_read_b128 v[44:47], v10 offset:52224
    ds_read_b128 v[48:51], v19 offset:19456
    s_waitcnt vmcnt(28) lgkmcnt(3)
    v_mfma_f32_32x32x16_bf16 v[52:67], v[196:199], v[28:31], v[52:67]
    v_mfma_f32_32x32x16_bf16 v[68:83], v[200:203], v[28:31], v[68:83]
    v_mfma_f32_32x32x16_bf16 v[84:99], v[196:199], v[32:35], v[84:99]
    v_mfma_f32_32x32x16_bf16 v[100:115], v[200:203], v[32:35], v[100:115]
    v_mfma_f32_32x32x16_bf16 v[116:131], v[196:199], v[36:39], v[116:131]
    v_mfma_f32_32x32x16_bf16 v[132:147], v[200:203], v[36:39], v[132:147]
    global_load_dwordx4 v[196:199], v17, s[40:41] offset:2048
    global_load_dwordx4 v[200:203], v17, s[42:43] offset:2048
    ds_read_b128 v[28:31], v10 offset:20480
    ds_read_b128 v[32:35], v10 offset:53248
    ds_read_b128 v[36:39], v19 offset:20480
    s_waitcnt vmcnt(28) lgkmcnt(3)
    v_mfma_f32_32x32x16_bf16 v[52:67], v[204:207], v[40:43], v[52:67]
    v_mfma_f32_32x32x16_bf16 v[68:83], v[208:211], v[40:43], v[68:83]
    v_mfma_f32_32x32x16_bf16 v[84:99], v[204:207], v[44:47], v[84:99]
    v_mfma_f32_32x32x16_bf16 v[100:115], v[208:211], v[44:47], v[100:115]
    v_mfma_f32_32x32x16_bf16 v[116:131], v[204:207], v[48:51], v[116:131]
    v_mfma_f32_32x32x16_bf16 v[132:147], v[208:211], v[48:51], v[132:147]
    global_load_dwordx4 v[204:207], v17, s[40:41] offset:3072
    global_load_dwordx4 v[208:211], v17, s[42:43] offset:3072
    ds_read_b128 v[40:43], v10 offset:21504
    ds_read_b128 v[44:47], v10 offset:54272
    ds_read_b128 v[48:51], v19 offset:21504
    s_waitcnt vmcnt(28) lgkmcnt(3)
    v_mfma_f32_32x32x16_bf16 v[52:67], v[212:215], v[28:31], v[52:67]
    v_mfma_f32_32x32x16_bf16 v[68:83], v[216:219], v[28:31], v[68:83]
    v_mfma_f32_32x32x16_bf16 v[84:99], v[212:215], v[32:35], v[84:99]
    v_mfma_f32_32x32x16_bf16 v[100:115], v[216:219], v[32:35], v[100:115]
    v_mfma_f32_32x32x16_bf16 v[116:131], v[212:215], v[36:39], v[116:131]
    v_mfma_f32_32x32x16_bf16 v[132:147], v[216:219], v[36:39], v[132:147]
    ds_read_b128 v[28:31], v10 offset:22528
    ds_read_b128 v[32:35], v10 offset:55296
    ds_read_b128 v[36:39], v19 offset:22528
    s_waitcnt vmcnt(26) lgkmcnt(3)
    v_mfma_f32_32x32x16_bf16 v[52:67], v[220:223], v[40:43], v[52:67]
    v_mfma_f32_32x32x16_bf16 v[68:83], v[224:227], v[40:43], v[68:83]
    v_mfma_f32_32x32x16_bf16 v[84:99], v[220:223], v[44:47], v[84:99]
    v_mfma_f32_32x32x16_bf16 v[100:115], v[224:227], v[44:47], v[100:115]
    v_mfma_f32_32x32x16_bf16 v[116:131], v[220:223], v[48:51], v[116:131]
    v_mfma_f32_32x32x16_bf16 v[132:147], v[224:227], v[48:51], v[132:147]
    s_min_u32 s5, s48, 2
    s_add_u32 s5, s5, s3
    s_min_u32 s5, s5, 63
    s_lshl_b32 s5, s5, 12
    s_add_u32 s5, s5, 8388608
    s_add_u32 s56, s30, s5
    s_addc_u32 s57, s31, 0
    v_and_b32 v2, 31, v1
    v_lshlrev_b32 v2, 7, v2
    v_lshrrev_b32 v3, 5, v1
    v_lshl_add_u32 v2, v3, 6, v2
    global_load_dwordx4 v[212:215], v2, s[56:57] offset:0
    global_load_dwordx4 v[216:219], v2, s[56:57] offset:16
    global_load_dwordx4 v[220:223], v2, s[56:57] offset:32
    global_load_dwordx4 v[224:227], v2, s[56:57] offset:48
    ds_read_b128 v[40:43], v10 offset:23552
    ds_read_b128 v[44:47], v10 offset:56320
    ds_read_b128 v[48:51], v19 offset:23552
    s_waitcnt vmcnt(22) lgkmcnt(3)
    v_mfma_f32_32x32x16_bf16 v[52:67], v[228:231], v[28:31], v[52:67]
    v_mfma_f32_32x32x16_bf16 v[68:83], v[232:235], v[28:31], v[68:83]
    v_mfma_f32_32x32x16_bf16 v[84:99], v[228:231], v[32:35], v[84:99]
    v_mfma_f32_32x32x16_bf16 v[100:115], v[232:235], v[32:35], v[100:115]
    v_mfma_f32_32x32x16_bf16 v[116:131], v[228:231], v[36:39], v[116:131]
    v_mfma_f32_32x32x16_bf16 v[132:147], v[232:235], v[36:39], v[132:147]
    v_mul_u32_u24 v3, 5504, v3
    v_and_b32 v4, 31, v1
    v_lshl_add_u32 v3, v4, 2, v3
    s_lshl_b32 s5, s49, 7
    s_add_u32 s5, s5, 9437184
    s_add_u32 s56, s30, s5
    s_addc_u32 s57, s31, 0
    global_load_dword v228, v3, s[56:57]
    s_add_u32 s56, s56, 11008
    s_addc_u32 s57, s57, 0
    global_load_dword v229, v3, s[56:57]
    s_add_u32 s56, s56, 11008
    s_addc_u32 s57, s57, 0
    global_load_dword v230, v3, s[56:57]
    s_add_u32 s56, s56, 11008
    s_addc_u32 s57, s57, 0
    global_load_dword v231, v3, s[56:57]
    s_add_u32 s56, s56, 11008
    s_addc_u32 s57, s57, 0
    global_load_dword v232, v3, s[56:57]
    s_add_u32 s56, s56, 11008
    s_addc_u32 s57, s57, 0
    global_load_dword v233, v3, s[56:57]
    s_add_u32 s56, s56, 11008
    s_addc_u32 s57, s57, 0
    global_load_dword v234, v3, s[56:57]
    s_add_u32 s56, s56, 11008
    s_addc_u32 s57, s57, 0
    global_load_dword v235, v3, s[56:57]
    s_waitcnt vmcnt(28) lgkmcnt(0)
    v_mfma_f32_32x32x16_bf16 v[52:67], v[236:239], v[40:43], v[52:67]
    v_mfma_f32_32x32x16_bf16 v[68:83], v[240:243], v[40:43], v[68:83]
    v_mfma_f32_32x32x16_bf16 v[84:99], v[236:239], v[44:47], v[84:99]
    v_mfma_f32_32x32x16_bf16 v[100:115], v[240:243], v[44:47], v[100:115]
    v_mfma_f32_32x32x16_bf16 v[116:131], v[236:239], v[48:51], v[116:131]
    v_mfma_f32_32x32x16_bf16 v[132:147], v[240:243], v[48:51], v[132:147]
    s_waitcnt vmcnt(26) lgkmcnt(0)
    s_barrier
    ds_read_b128 v[28:31], v10 offset:24576
    ds_read_b128 v[32:35], v10 offset:57344
    ds_read_b128 v[36:39], v19 offset:24576
    ds_read_b128 v[40:43], v10 offset:25600
    ds_read_b128 v[44:47], v10 offset:58368
    ds_read_b128 v[48:51], v19 offset:25600
    s_waitcnt vmcnt(26) lgkmcnt(3)
    v_mfma_f32_32x32x16_bf16 v[52:67], v[148:151], v[28:31], v[52:67]
    v_mfma_f32_32x32x16_bf16 v[68:83], v[152:155], v[28:31], v[68:83]
    v_mfma_f32_32x32x16_bf16 v[84:99], v[148:151], v[32:35], v[84:99]
    v_mfma_f32_32x32x16_bf16 v[100:115], v[152:155], v[32:35], v[100:115]
    v_mfma_f32_32x32x16_bf16 v[116:131], v[148:151], v[36:39], v[116:131]
    v_mfma_f32_32x32x16_bf16 v[132:147], v[152:155], v[36:39], v[132:147]
    ds_read_b128 v[28:31], v10 offset:26624
    ds_read_b128 v[32:35], v10 offset:59392
    ds_read_b128 v[36:39], v19 offset:26624
    s_waitcnt vmcnt(24) lgkmcnt(3)
    v_mfma_f32_32x32x16_bf16 v[52:67], v[156:159], v[40:43], v[52:67]
    v_mfma_f32_32x32x16_bf16 v[68:83], v[160:163], v[40:43], v[68:83]
    v_mfma_f32_32x32x16_bf16 v[84:99], v[156:159], v[44:47], v[84:99]
    v_mfma_f32_32x32x16_bf16 v[100:115], v[160:163], v[44:47], v[100:115]
    v_mfma_f32_32x32x16_bf16 v[116:131], v[156:159], v[48:51], v[116:131]
    v_mfma_f32_32x32x16_bf16 v[132:147], v[160:163], v[48:51], v[132:147]
    ds_read_b128 v[40:43], v10 offset:27648
    ds_read_b128 v[44:47], v10 offset:60416
    ds_read_b128 v[48:51], v19 offset:27648
    s_waitcnt vmcnt(22) lgkmcnt(3)
    v_mfma_f32_32x32x16_bf16 v[52:67], v[164:167], v[28:31], v[52:67]
    v_mfma_f32_32x32x16_bf16 v[68:83], v[168:171], v[28:31], v[68:83]
    v_mfma_f32_32x32x16_bf16 v[84:99], v[164:167], v[32:35], v[84:99]
    v_mfma_f32_32x32x16_bf16 v[100:115], v[168:171], v[32:35], v[100:115]
    v_mfma_f32_32x32x16_bf16 v[116:131], v[164:167], v[36:39], v[116:131]
    v_mfma_f32_32x32x16_bf16 v[132:147], v[168:171], v[36:39], v[132:147]
    ds_read_b128 v[28:31], v10 offset:28672
    ds_read_b128 v[32:35], v10 offset:61440
    ds_read_b128 v[36:39], v19 offset:28672
    s_waitcnt vmcnt(20) lgkmcnt(3)
    v_mfma_f32_32x32x16_bf16 v[52:67], v[172:175], v[40:43], v[52:67]
    v_mfma_f32_32x32x16_bf16 v[68:83], v[176:179], v[40:43], v[68:83]
    v_mfma_f32_32x32x16_bf16 v[84:99], v[172:175], v[44:47], v[84:99]
    v_mfma_f32_32x32x16_bf16 v[100:115], v[176:179], v[44:47], v[100:115]
    v_mfma_f32_32x32x16_bf16 v[116:131], v[172:175], v[48:51], v[116:131]
    v_mfma_f32_32x32x16_bf16 v[132:147], v[176:179], v[48:51], v[132:147]
    ds_read_b128 v[40:43], v10 offset:29696
    ds_read_b128 v[44:47], v10 offset:62464
    ds_read_b128 v[48:51], v19 offset:29696
    s_waitcnt vmcnt(18) lgkmcnt(3)
    v_mfma_f32_32x32x16_bf16 v[52:67], v[180:183], v[28:31], v[52:67]
    v_mfma_f32_32x32x16_bf16 v[68:83], v[184:187], v[28:31], v[68:83]
    v_mfma_f32_32x32x16_bf16 v[84:99], v[180:183], v[32:35], v[84:99]
    v_mfma_f32_32x32x16_bf16 v[100:115], v[184:187], v[32:35], v[100:115]
    v_mfma_f32_32x32x16_bf16 v[116:131], v[180:183], v[36:39], v[116:131]
    v_mfma_f32_32x32x16_bf16 v[132:147], v[184:187], v[36:39], v[132:147]
    s_waitcnt vmcnt(0)
    v_add_f32 v4, v212, v214
    v_add_f32 v5, v213, v215
    v_add_f32 v4, v4, v216
    v_add_f32 v5, v5, v217
    v_add_f32 v4, v4, v218
    v_add_f32 v5, v5, v219
    v_add_f32 v4, v4, v220
    v_add_f32 v5, v5, v221
    v_add_f32 v4, v4, v222
    v_add_f32 v5, v5, v223
    v_add_f32 v4, v4, v224
    v_add_f32 v5, v5, v225
    v_add_f32 v4, v4, v226
    v_add_f32 v5, v5, v227
    v_mov_b32 v2, v4
    v_mov_b32 v3, v5
    v_add_f32 v228, v228, v229
    v_add_f32 v228, v228, v230
    v_add_f32 v228, v228, v231
    v_add_f32 v228, v228, v232
    v_add_f32 v228, v228, v233
    v_add_f32 v228, v228, v234
    v_add_f32 v228, v228, v235
    v_permlane32_swap_b32 v4, v2
    v_permlane32_swap_b32 v5, v3
    s_nop 1
    v_add_f32 v4, v4, v2
    v_add_f32 v5, v5, v3
    v_mul_f32 v4, 0x3b000000, v4
    v_mul_f32 v5, 0x3b000000, v5
    v_fma_f32 v5, -v4, v4, v5
    v_max_f32 v5, 0, v5
    v_add_f32 v5, 0x3727c5ac, v5
    s_lshl_b32 s5, s48, 8
    s_add_u32 s6, s5, 98304
    v_lshl_add_u32 v2, v1, 2, s6
    ds_write_b32 v2, v228
    s_add_u32 s5, s5, 99328
    v_and_b32 v2, 31, v1
    v_lshl_add_u32 v2, v2, 3, s5
    ds_write_b64 v2, v[4:5]
    ds_read_b128 v[28:31], v10 offset:30720
    ds_read_b128 v[32:35], v10 offset:63488
    ds_read_b128 v[36:39], v19 offset:30720
    s_waitcnt vmcnt(16) lgkmcnt(3)
    v_mfma_f32_32x32x16_bf16 v[52:67], v[188:191], v[40:43], v[52:67]
    v_mfma_f32_32x32x16_bf16 v[68:83], v[192:195], v[40:43], v[68:83]
    v_mfma_f32_32x32x16_bf16 v[84:99], v[188:191], v[44:47], v[84:99]
    v_mfma_f32_32x32x16_bf16 v[100:115], v[192:195], v[44:47], v[100:115]
    v_mfma_f32_32x32x16_bf16 v[116:131], v[188:191], v[48:51], v[116:131]
    v_mfma_f32_32x32x16_bf16 v[132:147], v[192:195], v[48:51], v[132:147]
    ds_read_b128 v[40:43], v10 offset:31744
    ds_read_b128 v[44:47], v10 offset:64512
    ds_read_b128 v[48:51], v19 offset:31744
    s_waitcnt vmcnt(14) lgkmcnt(3)
    v_mfma_f32_32x32x16_bf16 v[52:67], v[196:199], v[28:31], v[52:67]
    v_mfma_f32_32x32x16_bf16 v[68:83], v[200:203], v[28:31], v[68:83]
    v_mfma_f32_32x32x16_bf16 v[84:99], v[196:199], v[32:35], v[84:99]
    v_mfma_f32_32x32x16_bf16 v[100:115], v[200:203], v[32:35], v[100:115]
    v_mfma_f32_32x32x16_bf16 v[116:131], v[196:199], v[36:39], v[116:131]
    v_mfma_f32_32x32x16_bf16 v[132:147], v[200:203], v[36:39], v[132:147]
    s_waitcnt vmcnt(12) lgkmcnt(0)
    v_mfma_f32_32x32x16_bf16 v[52:67], v[204:207], v[40:43], v[52:67]
    v_mfma_f32_32x32x16_bf16 v[68:83], v[208:211], v[40:43], v[68:83]
    v_mfma_f32_32x32x16_bf16 v[84:99], v[204:207], v[44:47], v[84:99]
    v_mfma_f32_32x32x16_bf16 v[100:115], v[208:211], v[44:47], v[100:115]
    v_mfma_f32_32x32x16_bf16 v[116:131], v[204:207], v[48:51], v[116:131]
    v_mfma_f32_32x32x16_bf16 v[132:147], v[208:211], v[48:51], v[132:147]
    v_lshrrev_b32 v2, 5, v1
    v_lshl_add_u32 v2, v2, 4, s6
    v_and_b32 v3, 31, v1
    v_lshlrev_b32 v3, 3, v3
    v_add_u32 v3, 99328, v3
    s_waitcnt lgkmcnt(0)
    s_barrier
    ds_read_b128 v[148:151], v2 offset:0
    ds_read_b128 v[164:167], v2 offset:128
    ds_read_b128 v[152:155], v2 offset:32
    ds_read_b128 v[168:171], v2 offset:160
    ds_read_b128 v[156:159], v2 offset:64
    ds_read_b128 v[172:175], v2 offset:192
    ds_read_b128 v[160:163], v2 offset:96
    ds_read_b128 v[176:179], v2 offset:224
    ds_read_b64 v[20:21], v3 offset:0
    ds_read_b64 v[22:23], v3 offset:256
    ds_read_b64 v[24:25], v3 offset:512
    s_cmp_gt_u32 s4, 42
    s_cbranch_scc1 L_k4_exit
    s_waitcnt lgkmcnt(0)
L_k4_ep0:
    s_mul_i32 s6, s60, 88064
    s_lshl_b32 s7, s4, 11
    s_add_u32 s6, s6, s7
    s_add_u32 s6, s6, 10485760
    s_add_u32 s56, s30, s6
    s_addc_u32 s57, s31, 0
    v_rsq_f32 v4, v21
    s_nop 0
    v_mul_f32 v4, 0xbfb8aa3b, v4
    v_pk_fma_f32 v[52:53], v[20:21], v[148:149], v[52:53] op_sel_hi:[0,1,1] neg_lo:[1,0,0] neg_hi:[1,0,0]
    v_pk_fma_f32 v[68:69], v[20:21], v[164:165], v[68:69] op_sel_hi:[0,1,1] neg_lo:[1,0,0] neg_hi:[1,0,0]
    v_pk_fma_f32 v[54:55], v[20:21], v[150:151], v[54:55] op_sel_hi:[0,1,1] neg_lo:[1,0,0] neg_hi:[1,0,0]
    v_pk_fma_f32 v[70:71], v[20:21], v[166:167], v[70:71] op_sel_hi:[0,1,1] neg_lo:[1,0,0] neg_hi:[1,0,0]
    v_pk_fma_f32 v[56:57], v[20:21], v[152:153], v[56:57] op_sel_hi:[0,1,1] neg_lo:[1,0,0] neg_hi:[1,0,0]
    v_pk_fma_f32 v[72:73], v[20:21], v[168:169], v[72:73] op_sel_hi:[0,1,1] neg_lo:[1,0,0] neg_hi:[1,0,0]
    v_pk_fma_f32 v[58:59], v[20:21], v[154:155], v[58:59] op_sel_hi:[0,1,1] neg_lo:[1,0,0] neg_hi:[1,0,0]
    v_pk_fma_f32 v[74:75], v[20:21], v[170:171], v[74:75] op_sel_hi:[0,1,1] neg_lo:[1,0,0] neg_hi:[1,0,0]
    v_pk_fma_f32 v[60:61], v[20:21], v[156:157], v[60:61] op_sel_hi:[0,1,1] neg_lo:[1,0,0] neg_hi:[1,0,0]
    v_pk_fma_f32 v[76:77], v[20:21], v[172:173], v[76:77] op_sel_hi:[0,1,1] neg_lo:[1,0,0] neg_hi:[1,0,0]
    v_pk_fma_f32 v[62:63], v[20:21], v[158:159], v[62:63] op_sel_hi:[0,1,1] neg_lo:[1,0,0] neg_hi:[1,0,0]
    v_pk_fma_f32 v[78:79], v[20:21], v[174:175], v[78:79] op_sel_hi:[0,1,1] neg_lo:[1,0,0] neg_hi:[1,0,0]
    v_pk_fma_f32 v[64:65], v[20:21], v[160:161], v[64:65] op_sel_hi:[0,1,1] neg_lo:[1,0,0] neg_hi:[1,0,0]
    v_pk_fma_f32 v[80:81], v[20:21], v[176:177], v[80:81] op_sel_hi:[0,1,1] neg_lo:[1,0,0] neg_hi:[1,0,0]
    v_pk_fma_f32 v[66:67], v[20:21], v[162:163], v[66:67] op_sel_hi:[0,1,1] neg_lo:[1,0,0] neg_hi:[1,0,0]
    v_pk_fma_f32 v[82:83], v[20:21], v[178:179], v[82:83] op_sel_hi:[0,1,1] neg_lo:[1,0,0] neg_hi:[1,0,0]
    v_pk_mul_f32 v[180:181], v[4:5], v[52:53] op_sel_hi:[0,1]
    v_pk_mul_f32 v[182:183], v[4:5], v[54:55] op_sel_hi:[0,1]
    v_pk_mul_f32 v[184:185], v[4:5], v[56:57] op_sel_hi:[0,1]
    v_pk_mul_f32 v[186:187], v[4:5], v[58:59] op_sel_hi:[0,1]
    v_pk_mul_f32 v[188:189], v[4:5], v[60:61] op_sel_hi:[0,1]
    v_pk_mul_f32 v[190:191], v[4:5], v[62:63] op_sel_hi:[0,1]
    v_pk_mul_f32 v[192:193], v[4:5], v[64:65] op_sel_hi:[0,1]
    v_pk_mul_f32 v[194:195], v[4:5], v[66:67] op_sel_hi:[0,1]
    v_exp_f32 v180, v180
    v_exp_f32 v181, v181
    v_exp_f32 v182, v182
    v_exp_f32 v183, v183
    v_exp_f32 v184, v184
    v_exp_f32 v185, v185
    v_exp_f32 v186, v186
    v_exp_f32 v187, v187
    v_exp_f32 v188, v188
    v_exp_f32 v189, v189
    v_exp_f32 v190, v190
    v_exp_f32 v191, v191
    v_exp_f32 v192, v192
    v_exp_f32 v193, v193
    v_exp_f32 v194, v194
    v_exp_f32 v195, v195
    v_pk_mul_f32 v[52:53], v[52:53], v[68:69]
    v_pk_mul_f32 v[54:55], v[54:55], v[70:71]
    v_pk_mul_f32 v[56:57], v[56:57], v[72:73]
    v_pk_mul_f32 v[58:59], v[58:59], v[74:75]
    v_pk_mul_f32 v[60:61], v[60:61], v[76:77]
    v_pk_mul_f32 v[62:63], v[62:63], v[78:79]
    v_pk_mul_f32 v[64:65], v[64:65], v[80:81]
    v_pk_mul_f32 v[66:67], v[66:67], v[82:83]
    v_pk_fma_f32 v[180:181], v[180:181], v[20:21], v[20:21] op_sel:[0,1,1] op_sel_hi:[1,1,1]
    v_pk_fma_f32 v[182:183], v[182:183], v[20:21], v[20:21] op_sel:[0,1,1] op_sel_hi:[1,1,1]
    v_pk_fma_f32 v[184:185], v[184:185], v[20:21], v[20:21] op_sel:[0,1,1] op_sel_hi:[1,1,1]
    v_pk_fma_f32 v[186:187], v[186:187], v[20:21], v[20:21] op_sel:[0,1,1] op_sel_hi:[1,1,1]
    v_pk_fma_f32 v[188:189], v[188:189], v[20:21], v[20:21] op_sel:[0,1,1] op_sel_hi:[1,1,1]
    v_pk_fma_f32 v[190:191], v[190:191], v[20:21], v[20:21] op_sel:[0,1,1] op_sel_hi:[1,1,1]
    v_pk_fma_f32 v[192:193], v[192:193], v[20:21], v[20:21] op_sel:[0,1,1] op_sel_hi:[1,1,1]
    v_pk_fma_f32 v[194:195], v[194:195], v[20:21], v[20:21] op_sel:[0,1,1] op_sel_hi:[1,1,1]
    v_rcp_f32 v180, v180
    v_rcp_f32 v181, v181
    v_rcp_f32 v182, v182
    v_rcp_f32 v183, v183
    v_rcp_f32 v184, v184
    v_rcp_f32 v185, v185
    v_rcp_f32 v186, v186
    v_rcp_f32 v187, v187
    v_rcp_f32 v188, v188
    v_rcp_f32 v189, v189
    v_rcp_f32 v190, v190
    v_rcp_f32 v191, v191
    v_rcp_f32 v192, v192
    v_rcp_f32 v193, v193
    v_rcp_f32 v194, v194
    v_rcp_f32 v195, v195
    s_nop 0
    v_pk_mul_f32 v[52:53], v[52:53], v[180:181]
    v_pk_mul_f32 v[54:55], v[54:55], v[182:183]
    v_pk_mul_f32 v[56:57], v[56:57], v[184:185]
    v_pk_mul_f32 v[58:59], v[58:59], v[186:187]
    v_pk_mul_f32 v[60:61], v[60:61], v[188:189]
    v_pk_mul_f32 v[62:63], v[62:63], v[190:191]
    v_pk_mul_f32 v[64:65], v[64:65], v[192:193]
    v_pk_mul_f32 v[66:67], v[66:67], v[194:195]
    v_cvt_pk_bf16_f32 v196, v52, v53
    v_cvt_pk_bf16_f32 v197, v54, v55
    v_cvt_pk_bf16_f32 v198, v56, v57
    v_cvt_pk_bf16_f32 v199, v58, v59
    v_cvt_pk_bf16_f32 v200, v60, v61
    v_cvt_pk_bf16_f32 v201, v62, v63
    v_cvt_pk_bf16_f32 v202, v64, v65
    v_cvt_pk_bf16_f32 v203, v66, v67
    s_nop 1
    v_permlane32_swap_b32 v196, v198
    v_permlane32_swap_b32 v197, v199
    v_permlane32_swap_b32 v200, v202
    v_permlane32_swap_b32 v201, v203
    s_nop 1
    global_store_dwordx4 v10, v[196:199], s[56:57] offset:0 sc0 sc1
    global_store_dwordx4 v10, v[200:203], s[56:57] offset:1024 sc0 sc1
    s_add_u32 s6, s3, 1
    s_cmp_gt_u32 s6, 63
    s_cbranch_scc1 L_k4_exit
L_k4_ep1:
    s_mul_i32 s6, s61, 88064
    s_lshl_b32 s7, s4, 11
    s_add_u32 s6, s6, s7
    s_add_u32 s6, s6, 10485760
    s_add_u32 s56, s30, s6
    s_addc_u32 s57, s31, 0
    v_rsq_f32 v4, v23
    s_nop 0
    v_mul_f32 v4, 0xbfb8aa3b, v4
    v_pk_fma_f32 v[84:85], v[22:23], v[148:149], v[84:85] op_sel_hi:[0,1,1] neg_lo:[1,0,0] neg_hi:[1,0,0]
    v_pk_fma_f32 v[100:101], v[22:23], v[164:165], v[100:101] op_sel_hi:[0,1,1] neg_lo:[1,0,0] neg_hi:[1,0,0]
    v_pk_fma_f32 v[86:87], v[22:23], v[150:151], v[86:87] op_sel_hi:[0,1,1] neg_lo:[1,0,0] neg_hi:[1,0,0]
    v_pk_fma_f32 v[102:103], v[22:23], v[166:167], v[102:103] op_sel_hi:[0,1,1] neg_lo:[1,0,0] neg_hi:[1,0,0]
    v_pk_fma_f32 v[88:89], v[22:23], v[152:153], v[88:89] op_sel_hi:[0,1,1] neg_lo:[1,0,0] neg_hi:[1,0,0]
    v_pk_fma_f32 v[104:105], v[22:23], v[168:169], v[104:105] op_sel_hi:[0,1,1] neg_lo:[1,0,0] neg_hi:[1,0,0]
    v_pk_fma_f32 v[90:91], v[22:23], v[154:155], v[90:91] op_sel_hi:[0,1,1] neg_lo:[1,0,0] neg_hi:[1,0,0]
    v_pk_fma_f32 v[106:107], v[22:23], v[170:171], v[106:107] op_sel_hi:[0,1,1] neg_lo:[1,0,0] neg_hi:[1,0,0]
    v_pk_fma_f32 v[92:93], v[22:23], v[156:157], v[92:93] op_sel_hi:[0,1,1] neg_lo:[1,0,0] neg_hi:[1,0,0]
    v_pk_fma_f32 v[108:109], v[22:23], v[172:173], v[108:109] op_sel_hi:[0,1,1] neg_lo:[1,0,0] neg_hi:[1,0,0]
    v_pk_fma_f32 v[94:95], v[22:23], v[158:159], v[94:95] op_sel_hi:[0,1,1] neg_lo:[1,0,0] neg_hi:[1,0,0]
    v_pk_fma_f32 v[110:111], v[22:23], v[174:175], v[110:111] op_sel_hi:[0,1,1] neg_lo:[1,0,0] neg_hi:[1,0,0]
    v_pk_fma_f32 v[96:97], v[22:23], v[160:161], v[96:97] op_sel_hi:[0,1,1] neg_lo:[1,0,0] neg_hi:[1,0,0]
    v_pk_fma_f32 v[112:113], v[22:23], v[176:177], v[112:113] op_sel_hi:[0,1,1] neg_lo:[1,0,0] neg_hi:[1,0,0]
    v_pk_fma_f32 v[98:99], v[22:23], v[162:163], v[98:99] op_sel_hi:[0,1,1] neg_lo:[1,0,0] neg_hi:[1,0,0]
    v_pk_fma_f32 v[114:115], v[22:23], v[178:179], v[114:115] op_sel_hi:[0,1,1] neg_lo:[1,0,0] neg_hi:[1,0,0]
    v_pk_mul_f32 v[180:181], v[4:5], v[84:85] op_sel_hi:[0,1]
    v_pk_mul_f32 v[182:183], v[4:5], v[86:87] op_sel_hi:[0,1]
    v_pk_mul_f32 v[184:185], v[4:5], v[88:89] op_sel_hi:[0,1]
    v_pk_mul_f32 v[186:187], v[4:5], v[90:91] op_sel_hi:[0,1]
    v_pk_mul_f32 v[188:189], v[4:5], v[92:93] op_sel_hi:[0,1]
    v_pk_mul_f32 v[190:191], v[4:5], v[94:95] op_sel_hi:[0,1]
    v_pk_mul_f32 v[192:193], v[4:5], v[96:97] op_sel_hi:[0,1]
    v_pk_mul_f32 v[194:195], v[4:5], v[98:99] op_sel_hi:[0,1]
    v_exp_f32 v180, v180
    v_exp_f32 v181, v181
    v_exp_f32 v182, v182
    v_exp_f32 v183, v183
    v_exp_f32 v184, v184
    v_exp_f32 v185, v185
    v_exp_f32 v186, v186
    v_exp_f32 v187, v187
    v_exp_f32 v188, v188
    v_exp_f32 v189, v189
    v_exp_f32 v190, v190
    v_exp_f32 v191, v191
    v_exp_f32 v192, v192
    v_exp_f32 v193, v193
    v_exp_f32 v194, v194
    v_exp_f32 v195, v195
    v_pk_mul_f32 v[84:85], v[84:85], v[100:101]
    v_pk_mul_f32 v[86:87], v[86:87], v[102:103]
    v_pk_mul_f32 v[88:89], v[88:89], v[104:105]
    v_pk_mul_f32 v[90:91], v[90:91], v[106:107]
    v_pk_mul_f32 v[92:93], v[92:93], v[108:109]
    v_pk_mul_f32 v[94:95], v[94:95], v[110:111]
    v_pk_mul_f32 v[96:97], v[96:97], v[112:113]
    v_pk_mul_f32 v[98:99], v[98:99], v[114:115]
    v_pk_fma_f32 v[180:181], v[180:181], v[22:23], v[22:23] op_sel:[0,1,1] op_sel_hi:[1,1,1]
    v_pk_fma_f32 v[182:183], v[182:183], v[22:23], v[22:23] op_sel:[0,1,1] op_sel_hi:[1,1,1]
    v_pk_fma_f32 v[184:185], v[184:185], v[22:23], v[22:23] op_sel:[0,1,1] op_sel_hi:[1,1,1]
    v_pk_fma_f32 v[186:187], v[186:187], v[22:23], v[22:23] op_sel:[0,1,1] op_sel_hi:[1,1,1]
    v_pk_fma_f32 v[188:189], v[188:189], v[22:23], v[22:23] op_sel:[0,1,1] op_sel_hi:[1,1,1]
    v_pk_fma_f32 v[190:191], v[190:191], v[22:23], v[22:23] op_sel:[0,1,1] op_sel_hi:[1,1,1]
    v_pk_fma_f32 v[192:193], v[192:193], v[22:23], v[22:23] op_sel:[0,1,1] op_sel_hi:[1,1,1]
    v_pk_fma_f32 v[194:195], v[194:195], v[22:23], v[22:23] op_sel:[0,1,1] op_sel_hi:[1,1,1]
    v_rcp_f32 v180, v180
    v_rcp_f32 v181, v181
    v_rcp_f32 v182, v182
    v_rcp_f32 v183, v183
    v_rcp_f32 v184, v184
    v_rcp_f32 v185, v185
    v_rcp_f32 v186, v186
    v_rcp_f32 v187, v187
    v_rcp_f32 v188, v188
    v_rcp_f32 v189, v189
    v_rcp_f32 v190, v190
    v_rcp_f32 v191, v191
    v_rcp_f32 v192, v192
    v_rcp_f32 v193, v193
    v_rcp_f32 v194, v194
    v_rcp_f32 v195, v195
    s_nop 0
    v_pk_mul_f32 v[84:85], v[84:85], v[180:181]
    v_pk_mul_f32 v[86:87], v[86:87], v[182:183]
    v_pk_mul_f32 v[88:89], v[88:89], v[184:185]
    v_pk_mul_f32 v[90:91], v[90:91], v[186:187]
    v_pk_mul_f32 v[92:93], v[92:93], v[188:189]
    v_pk_mul_f32 v[94:95], v[94:95], v[190:191]
    v_pk_mul_f32 v[96:97], v[96:97], v[192:193]
    v_pk_mul_f32 v[98:99], v[98:99], v[194:195]
    v_cvt_pk_bf16_f32 v196, v84, v85
    v_cvt_pk_bf16_f32 v197, v86, v87
    v_cvt_pk_bf16_f32 v198, v88, v89
    v_cvt_pk_bf16_f32 v199, v90, v91
    v_cvt_pk_bf16_f32 v200, v92, v93
    v_cvt_pk_bf16_f32 v201, v94, v95
    v_cvt_pk_bf16_f32 v202, v96, v97
    v_cvt_pk_bf16_f32 v203, v98, v99
    s_nop 1
    v_permlane32_swap_b32 v196, v198
    v_permlane32_swap_b32 v197, v199
    v_permlane32_swap_b32 v200, v202
    v_permlane32_swap_b32 v201, v203
    s_nop 1
    global_store_dwordx4 v10, v[196:199], s[56:57] offset:0 sc0 sc1
    global_store_dwordx4 v10, v[200:203], s[56:57] offset:1024 sc0 sc1
    s_add_u32 s6, s3, 2
    s_cmp_gt_u32 s6, 63
    s_cbranch_scc1 L_k4_exit
L_k4_ep2:
    s_mul_i32 s6, s62, 88064
    s_lshl_b32 s7, s4, 11
    s_add_u32 s6, s6, s7
    s_add_u32 s6, s6, 10485760
    s_add_u32 s56, s30, s6
    s_addc_u32 s57, s31, 0
    v_rsq_f32 v4, v25
    s_nop 0
    v_mul_f32 v4, 0xbfb8aa3b, v4
    v_pk_fma_f32 v[116:117], v[24:25], v[148:149], v[116:117] op_sel_hi:[0,1,1] neg_lo:[1,0,0] neg_hi:[1,0,0]
    v_pk_fma_f32 v[132:133], v[24:25], v[164:165], v[132:133] op_sel_hi:[0,1,1] neg_lo:[1,0,0] neg_hi:[1,0,0]
    v_pk_fma_f32 v[118:119], v[24:25], v[150:151], v[118:119] op_sel_hi:[0,1,1] neg_lo:[1,0,0] neg_hi:[1,0,0]
    v_pk_fma_f32 v[134:135], v[24:25], v[166:167], v[134:135] op_sel_hi:[0,1,1] neg_lo:[1,0,0] neg_hi:[1,0,0]
    v_pk_fma_f32 v[120:121], v[24:25], v[152:153], v[120:121] op_sel_hi:[0,1,1] neg_lo:[1,0,0] neg_hi:[1,0,0]
    v_pk_fma_f32 v[136:137], v[24:25], v[168:169], v[136:137] op_sel_hi:[0,1,1] neg_lo:[1,0,0] neg_hi:[1,0,0]
    v_pk_fma_f32 v[122:123], v[24:25], v[154:155], v[122:123] op_sel_hi:[0,1,1] neg_lo:[1,0,0] neg_hi:[1,0,0]
    v_pk_fma_f32 v[138:139], v[24:25], v[170:171], v[138:139] op_sel_hi:[0,1,1] neg_lo:[1,0,0] neg_hi:[1,0,0]
    v_pk_fma_f32 v[124:125], v[24:25], v[156:157], v[124:125] op_sel_hi:[0,1,1] neg_lo:[1,0,0] neg_hi:[1,0,0]
    v_pk_fma_f32 v[140:141], v[24:25], v[172:173], v[140:141] op_sel_hi:[0,1,1] neg_lo:[1,0,0] neg_hi:[1,0,0]
    v_pk_fma_f32 v[126:127], v[24:25], v[158:159], v[126:127] op_sel_hi:[0,1,1] neg_lo:[1,0,0] neg_hi:[1,0,0]
    v_pk_fma_f32 v[142:143], v[24:25], v[174:175], v[142:143] op_sel_hi:[0,1,1] neg_lo:[1,0,0] neg_hi:[1,0,0]
    v_pk_fma_f32 v[128:129], v[24:25], v[160:161], v[128:129] op_sel_hi:[0,1,1] neg_lo:[1,0,0] neg_hi:[1,0,0]
    v_pk_fma_f32 v[144:145], v[24:25], v[176:177], v[144:145] op_sel_hi:[0,1,1] neg_lo:[1,0,0] neg_hi:[1,0,0]
    v_pk_fma_f32 v[130:131], v[24:25], v[162:163], v[130:131] op_sel_hi:[0,1,1] neg_lo:[1,0,0] neg_hi:[1,0,0]
    v_pk_fma_f32 v[146:147], v[24:25], v[178:179], v[146:147] op_sel_hi:[0,1,1] neg_lo:[1,0,0] neg_hi:[1,0,0]
    v_pk_mul_f32 v[180:181], v[4:5], v[116:117] op_sel_hi:[0,1]
    v_pk_mul_f32 v[182:183], v[4:5], v[118:119] op_sel_hi:[0,1]
    v_pk_mul_f32 v[184:185], v[4:5], v[120:121] op_sel_hi:[0,1]
    v_pk_mul_f32 v[186:187], v[4:5], v[122:123] op_sel_hi:[0,1]
    v_pk_mul_f32 v[188:189], v[4:5], v[124:125] op_sel_hi:[0,1]
    v_pk_mul_f32 v[190:191], v[4:5], v[126:127] op_sel_hi:[0,1]
    v_pk_mul_f32 v[192:193], v[4:5], v[128:129] op_sel_hi:[0,1]
    v_pk_mul_f32 v[194:195], v[4:5], v[130:131] op_sel_hi:[0,1]
    v_exp_f32 v180, v180
    v_exp_f32 v181, v181
    v_exp_f32 v182, v182
    v_exp_f32 v183, v183
    v_exp_f32 v184, v184
    v_exp_f32 v185, v185
    v_exp_f32 v186, v186
    v_exp_f32 v187, v187
    v_exp_f32 v188, v188
    v_exp_f32 v189, v189
    v_exp_f32 v190, v190
    v_exp_f32 v191, v191
    v_exp_f32 v192, v192
    v_exp_f32 v193, v193
    v_exp_f32 v194, v194
    v_exp_f32 v195, v195
    v_pk_mul_f32 v[116:117], v[116:117], v[132:133]
    v_pk_mul_f32 v[118:119], v[118:119], v[134:135]
    v_pk_mul_f32 v[120:121], v[120:121], v[136:137]
    v_pk_mul_f32 v[122:123], v[122:123], v[138:139]
    v_pk_mul_f32 v[124:125], v[124:125], v[140:141]
    v_pk_mul_f32 v[126:127], v[126:127], v[142:143]
    v_pk_mul_f32 v[128:129], v[128:129], v[144:145]
    v_pk_mul_f32 v[130:131], v[130:131], v[146:147]
    v_pk_fma_f32 v[180:181], v[180:181], v[24:25], v[24:25] op_sel:[0,1,1] op_sel_hi:[1,1,1]
    v_pk_fma_f32 v[182:183], v[182:183], v[24:25], v[24:25] op_sel:[0,1,1] op_sel_hi:[1,1,1]
    v_pk_fma_f32 v[184:185], v[184:185], v[24:25], v[24:25] op_sel:[0,1,1] op_sel_hi:[1,1,1]
    v_pk_fma_f32 v[186:187], v[186:187], v[24:25], v[24:25] op_sel:[0,1,1] op_sel_hi:[1,1,1]
    v_pk_fma_f32 v[188:189], v[188:189], v[24:25], v[24:25] op_sel:[0,1,1] op_sel_hi:[1,1,1]
    v_pk_fma_f32 v[190:191], v[190:191], v[24:25], v[24:25] op_sel:[0,1,1] op_sel_hi:[1,1,1]
    v_pk_fma_f32 v[192:193], v[192:193], v[24:25], v[24:25] op_sel:[0,1,1] op_sel_hi:[1,1,1]
    v_pk_fma_f32 v[194:195], v[194:195], v[24:25], v[24:25] op_sel:[0,1,1] op_sel_hi:[1,1,1]
    v_rcp_f32 v180, v180
    v_rcp_f32 v181, v181
    v_rcp_f32 v182, v182
    v_rcp_f32 v183, v183
    v_rcp_f32 v184, v184
    v_rcp_f32 v185, v185
    v_rcp_f32 v186, v186
    v_rcp_f32 v187, v187
    v_rcp_f32 v188, v188
    v_rcp_f32 v189, v189
    v_rcp_f32 v190, v190
    v_rcp_f32 v191, v191
    v_rcp_f32 v192, v192
    v_rcp_f32 v193, v193
    v_rcp_f32 v194, v194
    v_rcp_f32 v195, v195
    s_nop 0
    v_pk_mul_f32 v[116:117], v[116:117], v[180:181]
    v_pk_mul_f32 v[118:119], v[118:119], v[182:183]
    v_pk_mul_f32 v[120:121], v[120:121], v[184:185]
    v_pk_mul_f32 v[122:123], v[122:123], v[186:187]
    v_pk_mul_f32 v[124:125], v[124:125], v[188:189]
    v_pk_mul_f32 v[126:127], v[126:127], v[190:191]
    v_pk_mul_f32 v[128:129], v[128:129], v[192:193]
    v_pk_mul_f32 v[130:131], v[130:131], v[194:195]
    v_cvt_pk_bf16_f32 v196, v116, v117
    v_cvt_pk_bf16_f32 v197, v118, v119
    v_cvt_pk_bf16_f32 v198, v120, v121
    v_cvt_pk_bf16_f32 v199, v122, v123
    v_cvt_pk_bf16_f32 v200, v124, v125
    v_cvt_pk_bf16_f32 v201, v126, v127
    v_cvt_pk_bf16_f32 v202, v128, v129
    v_cvt_pk_bf16_f32 v203, v130, v131
    s_nop 1
    v_permlane32_swap_b32 v196, v198
    v_permlane32_swap_b32 v197, v199
    v_permlane32_swap_b32 v200, v202
    v_permlane32_swap_b32 v201, v203
    s_nop 1
    global_store_dwordx4 v10, v[196:199], s[56:57] offset:0 sc0 sc1
    global_store_dwordx4 v10, v[200:203], s[56:57] offset:1024 sc0 sc1
L_k4_exit:
    s_endpgm

.globl k5_down_kernel
.p2align 8
.type k5_down_kernel,@function
k5_down_kernel:
    s_load_dwordx16 s[8:23], s[0:1], 0
    s_load_dwordx8 s[24:31], s[0:1], 64
    s_cmp_ge_u32 s2, 256
    s_cbranch_scc1 L_k5_down_kernel_exit
    s_lshr_b32 s5, s2, 3
    s_and_b32 s6, s2, 7
    s_lshr_b32 s3, s5, 3
    s_lshl_b32 s6, s6, 2
    s_add_u32 s3, s3, s6
    s_and_b32 s4, s5, 7
    v_and_b32 v1, 63, v0
    v_lshrrev_b32 v2, 6, v0
    s_nop 0
    v_readfirstlane_b32 s48, v2
    s_and_b32 s50, s48, 1
    s_lshr_b32 s51, s48, 1
    s_lshl_b32 s52, s48, 13
    v_lshlrev_b32 v11, 4, v1
    v_add_u32 v12, 4096, v11
    s_lshl_b32 s5, s3, 1
    s_add_u32 s5, s5, s50
    s_lshl_b32 s6, s4, 1
    s_add_u32 s6, s6, s50
    s_mul_i32 s5, s5, 88064
    s_mul_i32 s6, s6, 88064
    s_add_u32 s5, s5, 10485760
    s_add_u32 s6, s6, 22020096
    s_cmp_eq_u32 s51, 0
    s_cselect_b32 s5, s5, s6
    s_lshl_b32 s6, s50, 13
    v_add_u32 v13, s6, v11
    s_lshl_b32 s6, s51, 13
    s_add_u32 s6, s6, 16384
    v_add_u32 v14, s6, v11
    v_mov_b32 v10, 0x3f803f80
    v_mov_b32 v8, 0
    v_mov_b32 v9, 0
    s_waitcnt lgkmcnt(0)
    s_add_u32 s40, s30, s5
    s_addc_u32 s41, s31, 0
    s_mov_b32 s61, 0
    s_mov_b32 s60, 0
    s_add_u32 m0, s52, s61
    s_add_u32 s61, s61, 32768
    global_load_lds_dwordx4 v11, s[40:41] offset:0
    global_load_lds_dwordx4 v11, s[40:41] offset:1024
    global_load_lds_dwordx4 v11, s[40:41] offset:2048
    global_load_lds_dwordx4 v11, s[40:41] offset:3072
    s_add_u32 m0, m0, 4096
    s_cmp_eq_u32 s61, 163840
    s_cselect_b32 s61, 0, s61
    global_load_lds_dwordx4 v12, s[40:41] offset:0
    global_load_lds_dwordx4 v12, s[40:41] offset:1024
    global_load_lds_dwordx4 v12, s[40:41] offset:2048
    global_load_lds_dwordx4 v12, s[40:41] offset:3072
    s_add_u32 s40, s40, 8192
    s_addc_u32 s41, s41, 0
    v_and_b32 v2, 31, v1
    v_lshrrev_b32 v3, 5, v1
    v_lshlrev_b32 v24, 10, v2
    v_lshl_add_u32 v24, v3, 3, v24
    v_lshlrev_b32 v25, 4, v2
    v_lshl_add_u32 v25, v3, 3, v25
    s_lshl_b32 s5, s3, 1
    s_add_u32 s5, s5, s50
    s_lshl_b32 s6, s4, 1
    s_add_u32 s6, s6, s51
    s_lshl_b32 s7, s5, 15
    s_lshl_b32 s54, s6, 6
    s_add_u32 s7, s7, s54
    s_lshl_b32 s54, s5, 15
    s_lshl_b32 s55, s6, 11
    s_add_u32 s54, s54, s55
    s_add_u32 s54, s54, 6291456
    s_add_u32 s56, s30, s54
    s_addc_u32 s57, s31, 0
    s_add_u32 s58, s26, s7
    s_addc_u32 s59, s27, 0
    global_load_dwordx2 v[16:17], v25, s[56:57] offset:0
    global_load_dwordx2 v[18:19], v25, s[56:57] offset:512
    global_load_dwordx2 v[20:21], v25, s[56:57] offset:1024
    global_load_dwordx2 v[22:23], v25, s[56:57] offset:1536
    s_add_u32 m0, s52, s61
    s_add_u32 s61, s61, 32768
    global_load_lds_dwordx4 v11, s[40:41] offset:0
    global_load_lds_dwordx4 v11, s[40:41] offset:1024
    global_load_lds_dwordx4 v11, s[40:41] offset:2048
    global_load_lds_dwordx4 v11, s[40:41] offset:3072
    s_add_u32 m0, m0, 4096
    s_cmp_eq_u32 s61, 163840
    s_cselect_b32 s61, 0, s61
    global_load_lds_dwordx4 v12, s[40:41] offset:0
    global_load_lds_dwordx4 v12, s[40:41] offset:1024
    global_load_lds_dwordx4 v12, s[40:41] offset:2048
    global_load_lds_dwordx4 v12, s[40:41] offset:3072
    s_add_u32 s40, s40, 8192
    s_addc_u32 s41, s41, 0
    v_mov_b32 v32, 0
    v_mov_b32 v33, 0
    v_mov_b32 v34, 0
    v_mov_b32 v35, 0
    v_mov_b32 v36, 0
    v_mov_b32 v37, 0
    v_mov_b32 v38, 0
    v_mov_b32 v39, 0
    v_mov_b32 v40, 0
    v_mov_b32 v41, 0
    v_mov_b32 v42, 0
    v_mov_b32 v43, 0
    v_mov_b32 v44, 0
    v_mov_b32 v45, 0
    v_mov_b32 v46, 0
    v_mov_b32 v47, 0
    s_mov_b32 s62, 10
    s_mov_b32 s63, 0
L_k5_down_kernel_loop:
    s_waitcnt vmcnt(8)
    s_barrier
    s_cmp_lt_u32 s62, 2
    s_cbranch_scc1 L_k5_down_kernel_noiss
    s_add_u32 m0, s52, s61
    s_add_u32 s61, s61, 32768
    global_load_lds_dwordx4 v11, s[40:41] offset:0
    global_load_lds_dwordx4 v11, s[40:41] offset:1024
    global_load_lds_dwordx4 v11, s[40:41] offset:2048
    global_load_lds_dwordx4 v11, s[40:41] offset:3072
    s_add_u32 m0, m0, 4096
    s_cmp_eq_u32 s61, 163840
    s_cselect_b32 s61, 0, s61
    global_load_lds_dwordx4 v12, s[40:41] offset:0
    global_load_lds_dwordx4 v12, s[40:41] offset:1024
    global_load_lds_dwordx4 v12, s[40:41] offset:2048
    global_load_lds_dwordx4 v12, s[40:41] offset:3072
    s_add_u32 s40, s40, 8192
    s_addc_u32 s41, s41, 0
L_k5_down_kernel_noiss:
    v_add_u32 v2, s60, v13
    v_add_u32 v3, s60, v14
    ds_read_b128 v[64:67], v2 offset:0
    ds_read_b128 v[68:71], v3 offset:0
    ds_read_b128 v[72:75], v2 offset:1024
    ds_read_b128 v[76:79], v3 offset:1024
    ds_read_b128 v[80:83], v2 offset:2048
    ds_read_b128 v[84:87], v3 offset:2048
    ds_read_b128 v[88:91], v2 offset:3072
    ds_read_b128 v[92:95], v3 offset:3072
    ds_read_b128 v[96:99], v2 offset:4096
    ds_read_b128 v[100:103], v3 offset:4096
    ds_read_b128 v[104:107], v2 offset:5120
    ds_read_b128 v[108:111], v3 offset:5120
    s_add_u32 s60, s60, 32768
    s_cmp_eq_u32 s60, 163840
    s_cselect_b32 s60, 0, s60
    ds_read_b128 v[112:115], v2 offset:6144
    ds_read_b128 v[116:119], v3 offset:6144
    s_waitcnt lgkmcnt(12)
    v_mfma_f32_32x32x16_bf16 v[32:47], v[68:71], v[64:67], v[32:47]
    ds_read_b128 v[120:123], v2 offset:7168
    ds_read_b128 v[124:127], v3 offset:7168
    s_waitcnt lgkmcnt(12)
    v_mfma_f32_32x32x16_bf16 v[32:47], v[76:79], v[72:75], v[32:47]
    s_waitcnt lgkmcnt(10)
    v_mfma_f32_32x32x16_bf16 v[32:47], v[84:87], v[80:83], v[32:47]
    s_waitcnt lgkmcnt(8)
    v_mfma_f32_32x32x16_bf16 v[32:47], v[92:95], v[88:91], v[32:47]
    s_waitcnt lgkmcnt(6)
    v_mfma_f32_32x32x16_bf16 v[32:47], v[100:103], v[96:99], v[32:47]
    s_waitcnt lgkmcnt(4)
    v_mfma_f32_32x32x16_bf16 v[32:47], v[108:111], v[104:107], v[32:47]
    s_waitcnt lgkmcnt(2)
    v_mfma_f32_32x32x16_bf16 v[32:47], v[116:119], v[112:115], v[32:47]
    s_waitcnt lgkmcnt(0)
    v_mfma_f32_32x32x16_bf16 v[32:47], v[124:127], v[120:123], v[32:47]
    s_sub_u32 s62, s62, 1
    s_cmp_lg_u32 s62, 0
    s_cbranch_scc1 L_k5_down_kernel_loop
    s_waitcnt vmcnt(0)
    s_barrier
    v_add_u32 v2, s60, v13
    v_add_u32 v3, s60, v14
    ds_read_b128 v[64:67], v2 offset:0
    ds_read_b128 v[68:71], v3 offset:0
    ds_read_b128 v[72:75], v2 offset:1024
    ds_read_b128 v[76:79], v3 offset:1024
    ds_read_b128 v[80:83], v2 offset:2048
    ds_read_b128 v[84:87], v3 offset:2048
    ds_read_b128 v[88:91], v2 offset:3072
    ds_read_b128 v[92:95], v3 offset:3072
    ds_read_b128 v[96:99], v2 offset:4096
    ds_read_b128 v[100:103], v3 offset:4096
    ds_read_b128 v[104:107], v2 offset:5120
    ds_read_b128 v[108:111], v3 offset:5120
    s_add_u32 s60, s60, 32768
    s_cmp_eq_u32 s60, 163840
    s_cselect_b32 s60, 0, s60
    s_waitcnt lgkmcnt(10)
    v_mfma_f32_32x32x16_bf16 v[32:47], v[68:71], v[64:67], v[32:47]
    s_waitcnt lgkmcnt(8)
    v_mfma_f32_32x32x16_bf16 v[32:47], v[76:79], v[72:75], v[32:47]
    s_waitcnt lgkmcnt(6)
    v_mfma_f32_32x32x16_bf16 v[32:47], v[84:87], v[80:83], v[32:47]
    s_waitcnt lgkmcnt(4)
    v_mfma_f32_32x32x16_bf16 v[32:47], v[92:95], v[88:91], v[32:47]
    s_waitcnt lgkmcnt(2)
    v_mfma_f32_32x32x16_bf16 v[32:47], v[100:103], v[96:99], v[32:47]
    s_waitcnt lgkmcnt(0)
    v_mfma_f32_32x32x16_bf16 v[32:47], v[108:111], v[104:107], v[32:47]
    s_nop 15
    s_nop 7
L_k5_down_kernel_epi:
    v_lshlrev_b32 v2, 16, v16
    v_and_b32 v3, 0xffff0000, v16
    v_add_f32 v32, v32, v2
    v_add_f32 v33, v33, v3
    v_lshlrev_b32 v2, 16, v17
    v_and_b32 v3, 0xffff0000, v17
    v_add_f32 v34, v34, v2
    v_add_f32 v35, v35, v3
    v_lshlrev_b32 v2, 16, v18
    v_and_b32 v3, 0xffff0000, v18
    v_add_f32 v36, v36, v2
    v_add_f32 v37, v37, v3
    v_lshlrev_b32 v2, 16, v19
    v_and_b32 v3, 0xffff0000, v19
    v_add_f32 v38, v38, v2
    v_add_f32 v39, v39, v3
    v_lshlrev_b32 v2, 16, v20
    v_and_b32 v3, 0xffff0000, v20
    v_add_f32 v40, v40, v2
    v_add_f32 v41, v41, v3
    v_lshlrev_b32 v2, 16, v21
    v_and_b32 v3, 0xffff0000, v21
    v_add_f32 v42, v42, v2
    v_add_f32 v43, v43, v3
    v_lshlrev_b32 v2, 16, v22
    v_and_b32 v3, 0xffff0000, v22
    v_add_f32 v44, v44, v2
    v_add_f32 v45, v45, v3
    v_lshlrev_b32 v2, 16, v23
    v_and_b32 v3, 0xffff0000, v23
    v_add_f32 v46, v46, v2
    v_add_f32 v47, v47, v3
    v_cvt_pk_bf16_f32 v48, v32, v33
    v_cvt_pk_bf16_f32 v49, v34, v35
    v_cvt_pk_bf16_f32 v50, v36, v37
    v_cvt_pk_bf16_f32 v51, v38, v39
    v_cvt_pk_bf16_f32 v52, v40, v41
    v_cvt_pk_bf16_f32 v53, v42, v43
    v_cvt_pk_bf16_f32 v54, v44, v45
    v_cvt_pk_bf16_f32 v55, v46, v47
    v_lshrrev_b32 v2, 5, v1
    v_lshl_add_u32 v3, v2, 3, v24
    v_permlane32_swap_b32 v48, v50
    v_permlane32_swap_b32 v49, v51
    v_permlane32_swap_b32 v52, v54
    v_permlane32_swap_b32 v53, v55
    s_nop 1
    global_store_dwordx4 v3, v[48:51], s[58:59] offset:0
    global_store_dwordx4 v3, v[52:55], s[58:59] offset:32
    s_nop 0
L_k5_down_kernel_exit:
    s_endpgm

.section .rodata,"a"
.p2align 6
.amdhsa_kernel k1_qkv_kernel
  .amdhsa_next_free_vgpr 208
  .amdhsa_next_free_sgpr 102
  .amdhsa_accum_offset 208
  .amdhsa_group_segment_fixed_size 0
  .amdhsa_kernarg_size 96
  .amdhsa_user_sgpr_count 2
  .amdhsa_user_sgpr_kernarg_segment_ptr 1
  .amdhsa_system_sgpr_workgroup_id_x 1
.end_amdhsa_kernel

.p2align 6
.amdhsa_kernel k2_attn_kernel
  .amdhsa_next_free_vgpr 128
  .amdhsa_next_free_sgpr 102
  .amdhsa_accum_offset 128
  .amdhsa_group_segment_fixed_size 0
  .amdhsa_kernarg_size 96
  .amdhsa_user_sgpr_count 2
  .amdhsa_user_sgpr_kernarg_segment_ptr 1
  .amdhsa_system_sgpr_workgroup_id_x 1
.end_amdhsa_kernel

.p2align 6
.amdhsa_kernel k3_wo_kernel
  .amdhsa_next_free_vgpr 128
  .amdhsa_next_free_sgpr 102
  .amdhsa_accum_offset 128
  .amdhsa_group_segment_fixed_size 0
  .amdhsa_kernarg_size 96
  .amdhsa_user_sgpr_count 2
  .amdhsa_user_sgpr_kernarg_segment_ptr 1
  .amdhsa_system_sgpr_workgroup_id_x 1
.end_amdhsa_kernel

.p2align 6
.amdhsa_kernel k4_ffn_kernel
  .amdhsa_next_free_vgpr 248
  .amdhsa_next_free_sgpr 102
  .amdhsa_accum_offset 248
  .amdhsa_group_segment_fixed_size 0
  .amdhsa_kernarg_size 96
  .amdhsa_user_sgpr_count 2
  .amdhsa_user_sgpr_kernarg_segment_ptr 1
  .amdhsa_system_sgpr_workgroup_id_x 1
.end_amdhsa_kernel

.p2align 6
.amdhsa_kernel k5_down_kernel
  .amdhsa_next_free_vgpr 128
  .amdhsa_next_free_sgpr 102
  .amdhsa_accum_offset 128
  .amdhsa_group_segment_fixed_size 0
  .amdhsa_kernarg_size 96
  .amdhsa_user_sgpr_count 2
  .amdhsa_user_sgpr_kernarg_segment_ptr 1
  .amdhsa_system_sgpr_workgroup_id_x 1
.end_amdhsa_kernel
```
